```python
import torch

def _softmax(x, axis=-1):
    return torch.softmax(x, dim=axis)
def _gelu(x):
    return torch.nn.functional.gelu(x, approximate="tanh")
def _silu(x):
    return torch.nn.functional.silu(x)
def _sigmoid(x):
    return torch.sigmoid(x)
def _layernorm(x, axis=-1, eps=1e-5):
    m = x.mean(dim=axis, keepdim=True)
    v = x.var(dim=axis, keepdim=True, unbiased=False)
    return (x - m) / torch.sqrt(v + eps)
def _scatter_add(tgt, idx, src, axis=0):
    return tgt.clone().index_add_(axis, idx, src)
def _segment_sum(src, seg, n):
    out = torch.zeros((n,) + src.shape[1:], dtype=src.dtype)
    return out.index_add_(0, seg, src)
def _pad(x, pw):
    flat = tuple(v for pair in reversed(pw) for v in pair)
    return torch.nn.functional.pad(x, flat)

kernel_name = 'concat_heads__ssm_conv_s4__softmax_full_mha__prompt'

def setup_inputs():

    _w = (lambda a: (lambda t: t.to(torch.bfloat16) if t.is_floating_point() else t)(torch.as_tensor(a)))
    def _A_setup():
        B, L, D, N = 1, 2048, 512, 128
        A_re = -(lambda _x: torch.exp(torch.as_tensor(_x)))((lambda *s: torch.randn(*s, dtype=torch.bfloat16) * 6.4)(D, N))
        A_im = torch.pi * (lambda *s: torch.randn(*s, dtype=torch.bfloat16) * 0.1)(D, N)
        B_re = (lambda *s: torch.randn(*s, dtype=torch.bfloat16) * 0.2)(D, N)
        B_im = (lambda *s: torch.randn(*s, dtype=torch.bfloat16) * 0.2)(D, N)
        C_re = (lambda *s: torch.randn(*s, dtype=torch.bfloat16) * 0.2)(D, N)
        C_im = (lambda *s: torch.randn(*s, dtype=torch.bfloat16) * 0.2)(D, N)
        log_dt = (lambda *s: torch.randn(*s, dtype=torch.bfloat16) * 0.1)(D) * 0.5 - 4.0
        Dskip = (lambda *s: torch.randn(*s, dtype=torch.bfloat16) * 0.1)(D)
        return {
            "u": _w((lambda *s: torch.randn(*s, dtype=torch.bfloat16) * 0.05)(B, L, D)),
            "A_re": _w(A_re),
            "A_im": _w(A_im),
            "B_re": _w(B_re),
            "B_im": _w(B_im),
            "C_re": _w(C_re),
            "C_im": _w(C_im),
            "log_dt": _w(log_dt),
            "Dskip": _w(Dskip),
        }
    _A_in = _A_setup()

    def _B_setup():
        B, S, D = 1, 2048, 512
        return {
            "x": _w((lambda *s: torch.randn(*s, dtype=torch.bfloat16) * 0.2)(B, S, D)),
            "wqkv": _w((lambda *s: torch.randn(*s, dtype=torch.bfloat16) * 0.2)(D, 3 * D)),
            "wo": _w((lambda *s: torch.randn(*s, dtype=torch.bfloat16) * 0.05)(D, D)),
        }
    _B_in = _B_setup()

    return {
        "A_u": _A_in["u"],
        "A_A_re": _A_in["A_re"],
        "A_A_im": _A_in["A_im"],
        "A_B_re": _A_in["B_re"],
        "A_B_im": _A_in["B_im"],
        "A_C_re": _A_in["C_re"],
        "A_C_im": _A_in["C_im"],
        "A_log_dt": _A_in["log_dt"],
        "A_Dskip": _A_in["Dskip"],
        "B_x": _B_in["x"],
        "B_wqkv": _B_in["wqkv"],
        "B_wo": _B_in["wo"],
    }

def reference(A_u, A_A_re, A_A_im, A_B_re, A_B_im, A_C_re, A_C_im, A_log_dt, A_Dskip, B_x, B_wqkv, B_wo):
    def _A_ref(u, A_re, A_im, B_re, B_im, C_re, C_im, log_dt, Dskip):
        Bsz, L, D = u.shape
        dt = torch.exp(log_dt)[:, None]
        A = A_re + 1j * A_im
        Bc = B_re + 1j * B_im
        Cc = C_re + 1j * C_im
        logdA = dt * A
        dB = dt * Bc
        l = (lambda x, dt: x.to(dt))(torch.arange(L), A_re.dtype)
        P = torch.exp(logdA[:, :, None] * l[None, None, :])
        K = torch.einsum("dn,dnl,dn->dl", Cc, P, dB).real
        L2 = 2 * L
        Kp = _pad(K, ((0, 0), (0, L)))
        up = (lambda x, *d: x.permute(*d))(u, 0, 2, 1)
        up = _pad(up, ((0, 0), (0, 0), (0, L)))
        Kf = (lambda x, axes=(-2,-1): torch.fft.rfft2(x.float(), dim=axes))(Kp[:, None, :], axes=(-2, -1))
        Uf = (lambda x, axes=(-2,-1): torch.fft.rfft2(x.float(), dim=axes))(up[:, :, None, :], axes=(-2, -1))
        Yf = Uf * Kf[None, :, :, :]
        y = (lambda x, s, axes=(-2,-1): torch.fft.irfft2(x, s=s, dim=axes).to(torch.bfloat16))(Yf, (1, L2), axes=(-2, -1))[:, :, 0, :L]
        y = (lambda x, *d: x.permute(*d))(y, 0, 2, 1) + u * Dskip[None, None, :]
        return y

    def _B_ref(x, wqkv, wo):
        B, S, D = x.shape
        H = 32; Dh = D // H
        qkv = (lambda x, *d: x.permute(*d))((x @ wqkv).reshape(B, S, 3, H, Dh), 2, 0, 3, 1, 4)
        q, k, v = qkv[0], qkv[1], qkv[2]
        scale = Dh ** -0.5
        scores = torch.einsum("bhqd,bhkd->bhqk", q, k) * scale
        p = _softmax(scores, axis=-1)
        o = torch.einsum("bhqk,bhkd->bhqd", p, v)
        return (lambda x, *d: x.permute(*d))(o, 0, 2, 1, 3).reshape(B, S, D) @ wo

    a = _A_ref(A_u, A_A_re, A_A_im, A_B_re, A_B_im, A_C_re, A_C_im, A_log_dt, A_Dskip)
    b = _B_ref(B_x, B_wqkv, B_wo)
    return torch.concatenate([a, b], axis=-1)
```

```asm
; @launch grid=(256,1,1) block=(512,1,1) lds=163840
.amdgcn_target "amdgcn-amd-amdhsa--gfx950"
.text
.globl concat_heads__ssm_conv_s4__softmax_full_mha__prompt_kernel
.p2align 8
.type concat_heads__ssm_conv_s4__softmax_full_mha__prompt_kernel,@function
concat_heads__ssm_conv_s4__softmax_full_mha__prompt_kernel:
    s_cmp_ge_u32 s2, 256
    s_cbranch_scc1 L_end
    s_load_dwordx8 s[24:31], s[0:1], 64
    s_load_dwordx16 s[8:23], s[0:1], 0
    s_load_dwordx4 s[32:35], s[0:1], 96
    s_load_dwordx2 s[36:37], s[0:1], 112
    s_getpc_b64 s[4:5]
L_pc:
    s_and_b32 s3, s2, 0xf8
    v_add_u32 v14, s3, v0
    v_lshlrev_b32 v14, 7, v14
    v_min_u32 v14, L_end-L_pc-4, v14
    v_cmp_gt_u32 vcc, 8, v0
    s_and_saveexec_b64 s[6:7], vcc
    s_cbranch_execz L_nopf
    global_load_dword v47, v14, s[4:5]
L_nopf:
    s_mov_b64 exec, -1
    v_and_b32 v1, 63, v0
    v_lshrrev_b32 v14, 6, v0
    v_lshlrev_b32 v2, 4, v1
    v_mov_b32 v242, 0
    v_readfirstlane_b32 s66, v14
    s_and_b32 s64, s2, 7
    s_lshr_b32 s65, s2, 3
    s_and_b32 s6, s64, 3
    s_lshl_b32 s6, s6, 3
    s_lshr_b32 s71, s65, 2
    s_add_u32 s6, s6, s71
    s_and_b32 s7, s64, 4
    s_and_b32 s73, s65, 3
    s_add_u32 s7, s7, s73
    s_lshl_b32 s70, s64, 2
    s_add_u32 s70, s70, s73
    s_lshl_b32 s72, s64, 5
    s_add_u32 s72, s72, s65
    s_lshl_b32 s72, s72, 1
    s_lshl_b32 s3, s66, 10
    s_cmp_ge_u32 s66, 4
    s_cbranch_scc0 L_compute
    v_lshrrev_b32 v14, 3, v1
    v_and_b32 v15, 7, v1
    v_bfe_u32 v16, v1, 4, 1
    s_and_b32 s73, s66, 3
    s_lshl_b32 s77, s73, 11
    s_lshl_b32 s73, s73, 4
    v_add_u32 v17, s73, v14
    v_bfe_u32 v18, v17, 1, 3
    v_xor_b32 v18, v18, v15
    v_lshlrev_b32 v18, 4, v18
    s_lshl_b32 s74, s6, 16
    v_lshl_add_u32 v32, v17, 10, v18
    v_add_u32 v32, s74, v32
    v_xor_b32 v33, 0x2040, v32
    v_mul_u32_u24 v19, 0xc00, v17
    s_lshl_b32 s74, s7, 7
    v_add_u32 v19, s74, v19
    v_lshlrev_b32 v20, 1, v16
    v_xor_b32 v20, v20, v15
    v_lshl_add_u32 v34, v20, 4, v19
    v_xor_b32 v20, 4, v20
    v_lshl_add_u32 v35, v20, 4, v19
    v_add_u32 v35, 0x400, v35
    v_lshlrev_b32 v20, 2, v16
    v_xor_b32 v20, v20, v15
    v_lshl_add_u32 v36, v20, 4, v19
    v_add_u32 v36, 0x800, v36
    s_add_u32 s78, s7, s6
    s_lshl_b32 s78, s78, 1
    s_waitcnt lgkmcnt(0)
    s_mov_b32 s40, s26
    s_and_b32 s41, s27, 0xffff
    s_mov_b32 s42, 0x200000
    s_mov_b32 s43, 0x00020000
    s_mov_b32 s44, s28
    s_and_b32 s45, s29, 0xffff
    s_mov_b32 s46, 0x180000
    s_mov_b32 s47, 0x00020000
    s_lshl_b32 s76, s72, 1
    s_load_dword s67, s[36:37], 0
    s_load_dword s68, s[22:23], s76
    s_load_dword s69, s[24:25], s76
    s_add_u32 s20, s78, 0
    s_and_b32 s20, s20, 7
    s_add_u32 m0, s77, 0
    s_lshl_b32 s21, s20, 7
    buffer_load_dwordx4 v32, s[40:43], s21 offen lds
    s_add_u32 m0, s77, 0x400
    s_mul_i32 s22, s20, 0x30000
    buffer_load_dwordx4 v33, s[40:43], s21 offen lds
    s_add_u32 m0, s77, 0x2000
    s_add_u32 s23, s22, 0x6000
    buffer_load_dwordx4 v34, s[44:47], s22 offen lds
    s_add_u32 m0, s77, 0x2400
    s_nop 0
    buffer_load_dwordx4 v34, s[44:47], s23 offen lds
    s_add_u32 m0, s77, 0x4000
    s_nop 0
    buffer_load_dwordx4 v35, s[44:47], s22 offen lds
    s_add_u32 m0, s77, 0x4400
    s_nop 0
    buffer_load_dwordx4 v35, s[44:47], s23 offen lds
    s_add_u32 m0, s77, 0x6000
    s_nop 0
    buffer_load_dwordx4 v36, s[44:47], s22 offen lds
    s_add_u32 m0, s77, 0x6400
    s_nop 0
    buffer_load_dwordx4 v36, s[44:47], s23 offen lds
    s_mov_b32 s48, s36
    s_and_b32 s49, s37, 0xffff
    s_mov_b32 s50, 0x10000000
    s_mov_b32 s51, 0x00020000
    s_mov_b32 s56, s32
    s_and_b32 s57, s33, 0xffff
    s_mov_b32 s58, 0x400000
    s_mov_b32 s59, 0x00020000
    s_mov_b32 s60, s30
    s_and_b32 s61, s31, 0xffff
    s_mov_b32 s62, 0x80000
    s_mov_b32 s63, 0x00020000
    s_bfe_u32 s39, s66, 0x10001
    v_lshrrev_b32 v14, 5, v1
    v_and_b32 v15, 7, v1
    v_bfe_u32 v16, v1, 3, 2
    v_bfe_u32 v17, v1, 2, 2
    v_bfe_u32 v18, v1, 4, 1
    v_and_b32 v19, 15, v1
    v_lshrrev_b32 v20, 3, v1
    s_cmp_eq_u32 s39, 1
    s_mov_b32 s73, 146400
    s_cselect_b32 s73, 150560, s73
    s_mov_b32 s74, 154624
    s_cselect_b32 s74, 159232, s74
    s_mov_b32 s75, 70352
    s_cselect_b32 s75, 108368, s75
    v_and_b32 v22, 3, v1
    v_lshl_add_u32 v22, v18, 2, v22
    v_lshl_add_u32 v23, v14, 3, v17
    v_sub_u32 v22, v22, v23
    v_lshlrev_b32 v22, 3, v22
    v_add_u32 v224, s73, v22
    v_mul_u32_u24 v22, 0x480, v16
    v_add_u32 v24, v15, v14
    v_lshl_add_u32 v22, v24, 4, v22
    v_add_u32 v225, s74, v22
    v_mul_u32_u24 v22, 0x2520, v16
    v_mul_u32_u24 v24, 0x90, v15
    v_lshl_add_u32 v24, v14, 4, v24
    v_add3_u32 v226, v22, v24, s75
    s_lshl_b32 s9, s7, 5
    s_add_u32 s9, s9, s6
    s_lshl_b32 s9, s9, 7
    s_add_u32 s9, s9, 0x1000
    s_lshl_b32 s73, s64, 12
    s_add_u32 s10, s73, 0x1000
    s_add_u32 s17, s73, 0xa000
    s_lshl_b32 s18, s70, 16
    s_mov_b32 s97, 0
    s_cmp_ge_u32 s66, 4
    s_cselect_b32 s73, 1024, 0
    v_lshrrev_b32 v14, 5, v1
    v_and_b32 v15, 7, v1
    v_bfe_u32 v16, v1, 3, 2
    v_bfe_u32 v17, v1, 2, 2
    v_bfe_u32 v18, v1, 4, 1
    v_and_b32 v19, 15, v1
    v_lshrrev_b32 v20, 3, v1
    v_add_u32 v231, s73, v2
    v_lshlrev_b32 v22, 4, v19
    v_lshl_add_u32 v22, v14, 8, v22
    s_add_u32 s73, s73, 0x2000
    v_add_u32 v232, s73, v22
    v_lshlrev_b32 v234, 11, v1
    v_lshlrev_b32 v22, 2, v18
    v_xor_b32 v22, v22, v15
    v_lshlrev_b32 v22, 4, v22
    v_lshl_add_u32 v235, v20, 10, v22
    s_lshl_b32 s73, s66, 7
    s_add_u32 s73, s73, 32
    v_add_u32 v22, s73, v1
    v_lshrrev_b32 v24, 5, v22
    v_lshlrev_b32 v22, 2, v22
    v_lshl_add_u32 v22, v24, 4, v22
    v_add_u32 v227, 0x11240, v22
    v_add_u32 v22, s73, v1
    v_subrev_u32 v22, 1, v22
    v_lshrrev_b32 v24, 5, v22
    v_lshlrev_b32 v22, 2, v22
    v_lshl_add_u32 v22, v24, 4, v22
    v_add_u32 v228, 0x13760, v22
    v_add_u32 v22, s73, v1
    v_subrev_u32 v22, 2, v22
    v_lshrrev_b32 v24, 5, v22
    v_lshlrev_b32 v22, 2, v22
    v_lshl_add_u32 v22, v24, 4, v22
    v_add_u32 v229, 0x15c80, v22
    v_add_u32 v22, s73, v1
    v_subrev_u32 v22, 3, v22
    v_lshrrev_b32 v24, 5, v22
    v_lshlrev_b32 v22, 2, v22
    v_lshl_add_u32 v22, v24, 4, v22
    v_add_u32 v230, 0x181a0, v22
    s_lshl_b32 s73, s66, 18
    s_lshl_b32 s74, s72, 1
    s_add_u32 s11, s73, s74
    s_lshr_b32 s73, s73, 1
    s_add_u32 s73, s73, s74
    s_add_u32 s38, s73, 0x200000
    s_and_b32 s73, s65, 7
    s_lshl_b32 s73, s73, 7
    s_lshl_b32 s74, s66, 13
    s_add_u32 s12, s73, s74
    s_lshl_b32 s74, s71, 13
    s_add_u32 s74, s74, s18
    s_and_b32 s75, s66, 3
    s_lshl_b32 s75, s75, 11
    s_add_u32 s74, s74, s75
    s_add_u32 s19, s74, 0x100000
    v_bfe_u32 v14, v1, 4, 1
    v_bfe_u32 v15, v1, 2, 1
    v_lshl_or_b32 v14, v14, 1, v15
    v_bfe_u32 v15, v1, 3, 1
    v_and_b32 v16, 3, v1
    v_lshl_or_b32 v15, v15, 2, v16
    v_cmp_eq_u32 s[4:5], 0, v14
    v_cmp_eq_u32 vcc, 1, v14
    s_bitcmp1_b32 s66, 0
    s_mov_b32 s73, 1985229328
    s_cselect_b32 s73, 286261248, s73
    s_mov_b32 s74, 1126310144
    s_cselect_b32 s74, 286261248, s74
    s_mov_b32 s75, 571543552
    s_cselect_b32 s75, 286261248, s75
    s_mov_b32 s76, 269289472
    s_cselect_b32 s76, 420943123, s76
    v_mov_b32 v16, s75
    v_mov_b32 v17, s74
    v_cndmask_b32 v16, v16, v17, vcc
    v_mov_b32 v17, s73
    v_cndmask_b32 v16, v16, v17, s[4:5]
    v_lshlrev_b32 v15, 2, v15
    v_bfe_u32 v16, v16, v15, 4
    v_lshlrev_b32 v14, 3, v14
    v_bfe_u32 v14, s76, v14, 8
    v_add_u32 v14, v14, v16
    v_lshrrev_b32 v15, 5, v1
    v_and_b32 v16, 31, v1
    s_cselect_b32 s76, 2048, 0
    s_cselect_b32 s79, 0, -1
    s_bitcmp1_b32 s66, 1
    s_mov_b32 s73, 0
    s_cselect_b32 s73, 14256, s73
    s_mov_b32 s74, 98304
    s_cselect_b32 s74, 115200, s74
    s_mov_b32 s75, 146368
    s_cselect_b32 s75, 150528, s75
    s_add_u32 s75, s75, s76
    v_mul_u32_u24 v14, 0x210, v14
    v_lshl_add_u32 v17, v15, 4, s73
    v_add_u32 v244, v14, v17
    v_mul_u32_u24 v14, 0x210, v16
    v_lshl_add_u32 v17, v15, 4, s74
    v_add_u32 v245, v14, v17
    v_lshl_add_u32 v14, v15, 9, s75
    v_lshl_add_u32 v246, v16, 4, v14
    s_waitcnt lgkmcnt(0)
    s_add_u32 s67, s67, 1
    s_bitcmp1_b32 s66, 1
    s_cselect_b32 s73, 0, 16
    s_lshl_b32 s73, s69, s73
    s_and_b32 s73, s73, 0xffff0000
    s_and_b32 s73, s73, s79
    v_cmp_eq_u32 vcc, 0, v1
    v_mov_b32 v247, s73
    s_and_b32 s74, s66, 3
    s_lshl_b32 s74, s74, 8
    s_add_u32 s74, s74, 0x25c80
    v_cndmask_b32 v247, 0, v247, vcc
    v_lshl_add_u32 v248, v1, 1, s74
    v_mov_b32 v18, 0
    v_mov_b32 v19, 0
    v_mov_b32 v20, 0
    v_mov_b32 v21, 0
    v_lshrrev_b32 v14, 3, v1
    v_mul_u32_u24 v14, 0x480, v14
    v_and_b32 v15, 7, v1
    v_lshl_add_u32 v14, v15, 4, v14
    v_add_u32 v14, 0x25c00, v14
    v_bfe_u32 v15, v1, 2, 1
    v_mul_u32_u24 v15, 0x1040, v15
    v_and_b32 v16, 3, v1
    v_lshl_add_u32 v15, v16, 4, v15
    v_add_u32 v15, 0x23b80, v15
    v_lshlrev_b32 v16, 4, v16
    v_add_u32 v16, 0x23b40, v16
    ds_write_b128 v14, v[18:21]
    ds_write_b128 v15, v[18:21]
    ds_write_b128 v16, v[18:21]
    s_add_u32 s20, s78, 1
    s_and_b32 s20, s20, 7
    s_add_u32 m0, s77, 0x8000
    s_lshl_b32 s21, s20, 7
    buffer_load_dwordx4 v32, s[40:43], s21 offen lds
    s_add_u32 m0, s77, 0x8400
    s_mul_i32 s22, s20, 0x30000
    buffer_load_dwordx4 v33, s[40:43], s21 offen lds
    s_add_u32 m0, s77, 0xa000
    s_add_u32 s23, s22, 0x6000
    buffer_load_dwordx4 v34, s[44:47], s22 offen lds
    s_add_u32 m0, s77, 0xa400
    s_nop 0
    buffer_load_dwordx4 v34, s[44:47], s23 offen lds
    s_add_u32 m0, s77, 0xc000
    s_nop 0
    buffer_load_dwordx4 v35, s[44:47], s22 offen lds
    s_add_u32 m0, s77, 0xc400
    s_nop 0
    buffer_load_dwordx4 v35, s[44:47], s23 offen lds
    s_add_u32 m0, s77, 0xe000
    s_nop 0
    buffer_load_dwordx4 v36, s[44:47], s22 offen lds
    s_add_u32 m0, s77, 0xe400
    s_nop 0
    buffer_load_dwordx4 v36, s[44:47], s23 offen lds
    s_waitcnt vmcnt(8)
    s_barrier
    s_add_u32 s20, s78, 2
    s_and_b32 s20, s20, 7
    s_add_u32 m0, s77, 0x10000
    s_lshl_b32 s21, s20, 7
    buffer_load_dwordx4 v32, s[40:43], s21 offen lds
    s_add_u32 m0, s77, 0x10400
    s_mul_i32 s22, s20, 0x30000
    buffer_load_dwordx4 v33, s[40:43], s21 offen lds
    s_add_u32 m0, s77, 0x12000
    s_add_u32 s23, s22, 0x6000
    buffer_load_dwordx4 v34, s[44:47], s22 offen lds
    s_add_u32 m0, s77, 0x12400
    s_nop 0
    buffer_load_dwordx4 v34, s[44:47], s23 offen lds
    s_add_u32 m0, s77, 0x14000
    s_nop 0
    buffer_load_dwordx4 v35, s[44:47], s22 offen lds
    s_add_u32 m0, s77, 0x14400
    s_nop 0
    buffer_load_dwordx4 v35, s[44:47], s23 offen lds
    s_add_u32 m0, s77, 0x16000
    s_nop 0
    buffer_load_dwordx4 v36, s[44:47], s22 offen lds
    s_add_u32 m0, s77, 0x16400
    s_nop 0
    buffer_load_dwordx4 v36, s[44:47], s23 offen lds
    s_waitcnt vmcnt(8)
    s_barrier
    s_add_u32 s20, s78, 3
    s_and_b32 s20, s20, 7
    s_add_u32 m0, s77, 0
    s_lshl_b32 s21, s20, 7
    buffer_load_dwordx4 v32, s[40:43], s21 offen lds
    s_add_u32 m0, s77, 0x400
    s_mul_i32 s22, s20, 0x30000
    buffer_load_dwordx4 v33, s[40:43], s21 offen lds
    s_add_u32 m0, s77, 0x2000
    s_add_u32 s23, s22, 0x6000
    buffer_load_dwordx4 v34, s[44:47], s22 offen lds
    s_add_u32 m0, s77, 0x2400
    s_nop 0
    buffer_load_dwordx4 v34, s[44:47], s23 offen lds
    s_add_u32 m0, s77, 0x4000
    s_nop 0
    buffer_load_dwordx4 v35, s[44:47], s22 offen lds
    s_add_u32 m0, s77, 0x4400
    s_nop 0
    buffer_load_dwordx4 v35, s[44:47], s23 offen lds
    s_add_u32 m0, s77, 0x6000
    s_nop 0
    buffer_load_dwordx4 v36, s[44:47], s22 offen lds
    s_add_u32 m0, s77, 0x6400
    s_nop 0
    buffer_load_dwordx4 v36, s[44:47], s23 offen lds
    s_waitcnt vmcnt(8)
    s_barrier
    s_add_u32 s20, s78, 4
    s_and_b32 s20, s20, 7
    s_add_u32 m0, s77, 0x8000
    s_lshl_b32 s21, s20, 7
    buffer_load_dwordx4 v32, s[40:43], s21 offen lds
    s_add_u32 m0, s77, 0x8400
    s_mul_i32 s22, s20, 0x30000
    buffer_load_dwordx4 v33, s[40:43], s21 offen lds
    s_add_u32 m0, s77, 0xa000
    s_add_u32 s23, s22, 0x6000
    buffer_load_dwordx4 v34, s[44:47], s22 offen lds
    s_add_u32 m0, s77, 0xa400
    s_nop 0
    buffer_load_dwordx4 v34, s[44:47], s23 offen lds
    s_add_u32 m0, s77, 0xc000
    s_nop 0
    buffer_load_dwordx4 v35, s[44:47], s22 offen lds
    s_add_u32 m0, s77, 0xc400
    s_nop 0
    buffer_load_dwordx4 v35, s[44:47], s23 offen lds
    s_add_u32 m0, s77, 0xe000
    s_nop 0
    buffer_load_dwordx4 v36, s[44:47], s22 offen lds
    s_add_u32 m0, s77, 0xe400
    s_nop 0
    buffer_load_dwordx4 v36, s[44:47], s23 offen lds
    s_waitcnt vmcnt(8)
    s_barrier
    s_add_u32 s20, s78, 5
    s_and_b32 s20, s20, 7
    s_add_u32 m0, s77, 0x10000
    s_lshl_b32 s21, s20, 7
    buffer_load_dwordx4 v32, s[40:43], s21 offen lds
    s_add_u32 m0, s77, 0x10400
    s_mul_i32 s22, s20, 0x30000
    buffer_load_dwordx4 v33, s[40:43], s21 offen lds
    s_add_u32 m0, s77, 0x12000
    s_add_u32 s23, s22, 0x6000
    buffer_load_dwordx4 v34, s[44:47], s22 offen lds
    s_add_u32 m0, s77, 0x12400
    s_nop 0
    buffer_load_dwordx4 v34, s[44:47], s23 offen lds
    s_add_u32 m0, s77, 0x14000
    s_nop 0
    buffer_load_dwordx4 v35, s[44:47], s22 offen lds
    s_add_u32 m0, s77, 0x14400
    s_nop 0
    buffer_load_dwordx4 v35, s[44:47], s23 offen lds
    s_add_u32 m0, s77, 0x16000
    s_nop 0
    buffer_load_dwordx4 v36, s[44:47], s22 offen lds
    s_add_u32 m0, s77, 0x16400
    s_nop 0
    buffer_load_dwordx4 v36, s[44:47], s23 offen lds
    s_waitcnt vmcnt(8)
    s_barrier
    s_add_u32 s20, s78, 6
    s_and_b32 s20, s20, 7
    s_add_u32 m0, s77, 0
    s_lshl_b32 s21, s20, 7
    buffer_load_dwordx4 v32, s[40:43], s21 offen lds
    s_add_u32 m0, s77, 0x400
    s_mul_i32 s22, s20, 0x30000
    buffer_load_dwordx4 v33, s[40:43], s21 offen lds
    s_add_u32 m0, s77, 0x2000
    s_add_u32 s23, s22, 0x6000
    buffer_load_dwordx4 v34, s[44:47], s22 offen lds
    s_add_u32 m0, s77, 0x2400
    s_nop 0
    buffer_load_dwordx4 v34, s[44:47], s23 offen lds
    s_add_u32 m0, s77, 0x4000
    s_nop 0
    buffer_load_dwordx4 v35, s[44:47], s22 offen lds
    s_add_u32 m0, s77, 0x4400
    s_nop 0
    buffer_load_dwordx4 v35, s[44:47], s23 offen lds
    s_add_u32 m0, s77, 0x6000
    s_nop 0
    buffer_load_dwordx4 v36, s[44:47], s22 offen lds
    s_add_u32 m0, s77, 0x6400
    s_nop 0
    buffer_load_dwordx4 v36, s[44:47], s23 offen lds
    s_waitcnt vmcnt(8)
    s_barrier
    s_add_u32 s20, s78, 7
    s_and_b32 s20, s20, 7
    s_add_u32 m0, s77, 0x8000
    s_lshl_b32 s21, s20, 7
    buffer_load_dwordx4 v32, s[40:43], s21 offen lds
    s_add_u32 m0, s77, 0x8400
    s_mul_i32 s22, s20, 0x30000
    buffer_load_dwordx4 v33, s[40:43], s21 offen lds
    s_add_u32 m0, s77, 0xa000
    s_add_u32 s23, s22, 0x6000
    buffer_load_dwordx4 v34, s[44:47], s22 offen lds
    s_add_u32 m0, s77, 0xa400
    s_nop 0
    buffer_load_dwordx4 v34, s[44:47], s23 offen lds
    s_add_u32 m0, s77, 0xc000
    s_nop 0
    buffer_load_dwordx4 v35, s[44:47], s22 offen lds
    s_add_u32 m0, s77, 0xc400
    s_nop 0
    buffer_load_dwordx4 v35, s[44:47], s23 offen lds
    s_add_u32 m0, s77, 0xe000
    s_nop 0
    buffer_load_dwordx4 v36, s[44:47], s22 offen lds
    s_add_u32 m0, s77, 0xe400
    s_nop 0
    buffer_load_dwordx4 v36, s[44:47], s23 offen lds
    s_lshl_b32 s78, s64, 12
    s_add_u32 s78, s78, 0x20000
    v_lshlrev_b32 v42, 7, v1
    s_mov_b32 exec_hi, 0
    buffer_load_dword v39, v42, s[48:51], s78 offen sc1
    s_mov_b32 exec_hi, -1
    s_waitcnt vmcnt(9)
    s_barrier
    s_waitcnt vmcnt(1)
    s_barrier
    v_lshlrev_b32 v14, 7, v1
    s_mov_b32 s79, 0
    s_mov_b32 exec_hi, 0
    s_waitcnt vmcnt(0)
    s_branch L_poll0_chk
L_poll0:
L_poll0_go:
    buffer_load_dword v39, v14, s[48:51], s78 offen sc1
    s_add_u32 s79, s79, 1
    s_waitcnt vmcnt(0)
L_poll0_chk:
    v_cmp_ne_u32 vcc, s67, v39
    s_cmp_gt_u32 s79, 0x4000
    s_cbranch_scc1 L_poll0_done
    s_cmp_lg_u64 vcc, 0
    s_cbranch_scc1 L_poll0
L_poll0_done:
    s_mov_b32 exec_hi, -1
    s_lshl_b32 s73, s64, 5
    s_add_u32 s73, s73, s65
    s_lshl_b32 s73, s73, 13
    s_add_u32 s73, s73, s77
    s_add_u32 s73, s73, 0x900000
    buffer_load_dwordx4 v[80:83], v2, s[48:51], s73 offen sc1
    buffer_load_dwordx4 v[84:87], v2, s[48:51], s73 offen offset:1024 sc1
    s_barrier
    ds_read_b128 v[96:99], v244 offset:0
    ds_read_b128 v[128:131], v245 offset:0
    ds_read_b128 v[100:103], v244 offset:32
    ds_read_b128 v[132:135], v245 offset:32
    ds_read_b128 v[104:107], v244 offset:64
    ds_read_b128 v[136:139], v245 offset:64
    ds_read_b128 v[108:111], v244 offset:96
    ds_read_b128 v[140:143], v245 offset:96
    ds_read_b128 v[112:115], v244 offset:128
    ds_read_b128 v[144:147], v245 offset:128
    ds_read_b128 v[116:119], v244 offset:160
    ds_read_b128 v[148:151], v245 offset:160
    ds_read_b128 v[120:123], v244 offset:192
    ds_read_b128 v[152:155], v245 offset:192
    v_and_b32 v14, 1, v1
    v_cmp_eq_u32 vcc, 0, v14
    s_waitcnt lgkmcnt(12)
    v_mfma_f32_32x32x16_bf16 v[160:175], v[96:99], v[128:131], 0
    ds_read_b128 v[124:127], v244 offset:224
    ds_read_b128 v[156:159], v245 offset:224
    s_waitcnt lgkmcnt(12)
    v_mfma_f32_32x32x16_bf16 v[160:175], v[100:103], v[132:135], v[160:175]
    ds_read_b128 v[96:99], v244 offset:256
    ds_read_b128 v[128:131], v245 offset:256
    s_waitcnt lgkmcnt(12)
    v_mfma_f32_32x32x16_bf16 v[160:175], v[104:107], v[136:139], v[160:175]
    ds_read_b128 v[100:103], v244 offset:288
    ds_read_b128 v[132:135], v245 offset:288
    s_waitcnt lgkmcnt(12)
    v_mfma_f32_32x32x16_bf16 v[160:175], v[108:111], v[140:143], v[160:175]
    ds_read_b128 v[104:107], v244 offset:320
    ds_read_b128 v[136:139], v245 offset:320
    s_waitcnt lgkmcnt(12)
    v_mfma_f32_32x32x16_bf16 v[160:175], v[112:115], v[144:147], v[160:175]
    ds_read_b128 v[108:111], v244 offset:352
    ds_read_b128 v[140:143], v245 offset:352
    s_waitcnt lgkmcnt(12)
    v_mfma_f32_32x32x16_bf16 v[160:175], v[116:119], v[148:151], v[160:175]
    ds_read_b128 v[112:115], v244 offset:384
    ds_read_b128 v[144:147], v245 offset:384
    s_waitcnt lgkmcnt(12)
    v_mfma_f32_32x32x16_bf16 v[160:175], v[120:123], v[152:155], v[160:175]
    ds_read_b128 v[116:119], v244 offset:416
    ds_read_b128 v[148:151], v245 offset:416
    s_waitcnt lgkmcnt(12)
    v_mfma_f32_32x32x16_bf16 v[160:175], v[124:127], v[156:159], v[160:175]
    ds_read_b128 v[120:123], v244 offset:448
    ds_read_b128 v[152:155], v245 offset:448
    s_waitcnt lgkmcnt(12)
    v_mfma_f32_32x32x16_bf16 v[160:175], v[96:99], v[128:131], v[160:175]
    ds_read_b128 v[124:127], v244 offset:480
    ds_read_b128 v[156:159], v245 offset:480
    s_waitcnt lgkmcnt(12)
    v_mfma_f32_32x32x16_bf16 v[160:175], v[100:103], v[132:135], v[160:175]
    s_waitcnt lgkmcnt(10)
    v_mfma_f32_32x32x16_bf16 v[160:175], v[104:107], v[136:139], v[160:175]
    s_waitcnt vmcnt(0)
    ds_write_b16 v248, v80 offset:0
    ds_write_b16_d16_hi v248, v80 offset:4608
    ds_write_b16 v248, v81 offset:1152
    s_waitcnt lgkmcnt(11)
    v_mfma_f32_32x32x16_bf16 v[160:175], v[108:111], v[140:143], v[160:175]
    ds_write_b16_d16_hi v248, v81 offset:5760
    ds_write_b16 v248, v82 offset:2304
    ds_write_b16_d16_hi v248, v82 offset:6912
    s_waitcnt lgkmcnt(12)
    v_mfma_f32_32x32x16_bf16 v[160:175], v[112:115], v[144:147], v[160:175]
    ds_write_b16 v248, v83 offset:3456
    ds_write_b16_d16_hi v248, v83 offset:8064
    ds_write_b16 v248, v84 offset:128
    s_waitcnt lgkmcnt(13)
    v_mfma_f32_32x32x16_bf16 v[160:175], v[116:119], v[148:151], v[160:175]
    ds_write_b16_d16_hi v248, v84 offset:4736
    ds_write_b16 v248, v85 offset:1280
    ds_write_b16_d16_hi v248, v85 offset:5888
    s_waitcnt lgkmcnt(14)
    v_mfma_f32_32x32x16_bf16 v[160:175], v[120:123], v[152:155], v[160:175]
    ds_write_b16 v248, v86 offset:2432
    ds_write_b16_d16_hi v248, v86 offset:7040
    ds_write_b16 v248, v87 offset:3584
    s_waitcnt lgkmcnt(15)
    v_mfma_f32_32x32x16_bf16 v[160:175], v[124:127], v[156:159], v[160:175]
    ds_write_b16_d16_hi v248, v87 offset:8192
    s_nop 10
    v_add_f32 v160, v160, v247
    s_bitcmp1_b32 s66, 0
    s_cbranch_scc0 L_kg_nofix
    v_cndmask_b32 v164, v165, v163, vcc
    v_cndmask_b32 v172, v173, v171, vcc
L_kg_nofix:
    v_cvt_pk_bf16_f32 v96, v160, v161
    v_cvt_pk_bf16_f32 v97, v162, v163
    v_cvt_pk_bf16_f32 v98, v164, v165
    v_cvt_pk_bf16_f32 v99, v166, v167
    v_cvt_pk_bf16_f32 v100, v168, v169
    v_cvt_pk_bf16_f32 v101, v170, v171
    v_cvt_pk_bf16_f32 v102, v172, v173
    v_cvt_pk_bf16_f32 v103, v174, v175
    ds_write_b128 v246, v[96:99]
    ds_write_b128 v246, v[100:103] offset:1024
    s_branch L_gemm_done
L_compute:
    s_bfe_u32 s73, s66, 0x10001
    s_add_u32 s73, s73, s72
    s_lshl_b32 s73, s73, 8
    s_and_b32 s74, s66, 1
    s_lshl_b32 s74, s74, 7
    s_add_u32 s73, s73, s74
    v_lshl_add_u32 v3, v1, 1, s73
    s_waitcnt lgkmcnt(0)
    global_load_ushort v4, v3, s[10:11]
    global_load_ushort v5, v3, s[12:13]
    global_load_ushort v6, v3, s[14:15]
    global_load_ushort v7, v3, s[16:17]
    global_load_ushort v8, v3, s[18:19]
    global_load_ushort v9, v3, s[20:21]
    s_lshl_b32 s76, s72, 1
    s_load_dword s67, s[36:37], 0
    s_load_dword s68, s[22:23], s76
    s_load_dword s69, s[24:25], s76
    s_mov_b32 s52, s8
    s_and_b32 s53, s9, 0xffff
    s_mov_b32 s54, 0x200000
    s_mov_b32 s55, 0x00020000
    s_bfe_u32 s74, s66, 0x10001
    s_and_b32 s73, s66, 1
    v_and_b32 v14, 7, v1
    v_bfe_u32 v15, v1, 3, 2
    s_lshl_b32 s73, s73, 2
    v_add_u32 v15, s73, v15
    s_lshl_b32 s75, s65, 1
    s_add_u32 s74, s74, s75
    s_lshl_b32 s74, s74, 3
    v_add_u32 v14, s74, v14
    v_lshlrev_b32 v16, 4, v15
    v_lshl_add_u32 v30, v14, 12, v16
    v_lshlrev_b32 v14, 4, v14
    v_lshl_add_u32 v31, v15, 15, v14
    s_lshl_b32 s73, s64, 7
    s_mov_b32 exec_hi, 0
    buffer_load_dwordx4 v[196:199], v30, s[52:55], s73 offen offset:0
    buffer_load_dwordx4 v[200:203], v30, s[52:55], s73 offen offset:1024
    buffer_load_dwordx4 v[204:207], v30, s[52:55], s73 offen offset:2048
    buffer_load_dwordx4 v[208:211], v30, s[52:55], s73 offen offset:3072
    s_mov_b32 exec_hi, -1
    s_mov_b32 s48, s36
    s_and_b32 s49, s37, 0xffff
    s_mov_b32 s50, 0x10000000
    s_mov_b32 s51, 0x00020000
    s_mov_b32 s56, s32
    s_and_b32 s57, s33, 0xffff
    s_mov_b32 s58, 0x400000
    s_mov_b32 s59, 0x00020000
    s_mov_b32 s60, s30
    s_and_b32 s61, s31, 0xffff
    s_mov_b32 s62, 0x80000
    s_mov_b32 s63, 0x00020000
    v_and_b32 v14, 19, v1
    v_bfe_u32 v15, v1, 2, 1
    v_lshl_or_b32 v14, v15, 3, v14
    v_bfe_u32 v15, v1, 3, 1
    v_lshl_or_b32 v14, v15, 2, v14
    v_lshrrev_b32 v15, 5, v1
    v_lshlrev_b32 v222, 4, v14
    v_lshl_add_u32 v222, v15, 9, v222
    s_and_b32 s73, s66, 1
    s_lshl_b32 s74, s73, 5
    v_add_u32 v14, s74, v14
    v_bfe_u32 v16, v14, 1, 3
    v_xor_b32 v16, v16, v15
    v_lshlrev_b32 v16, 4, v16
    v_lshl_add_u32 v32, v14, 7, v16
    v_xor_b32 v33, 32, v32
    v_xor_b32 v34, 64, v32
    v_xor_b32 v35, 0x60, v32
    v_bfe_u32 v16, v1, 2, 2
    v_lshl_add_u32 v17, v15, 3, v16
    v_lshlrev_b32 v17, 7, v17
    v_bfe_u32 v18, v1, 4, 1
    v_bfe_u32 v19, v1, 3, 1
    v_and_b32 v20, 1, v1
    v_bfe_u32 v21, v1, 1, 1
    s_and_b32 s75, s66, 2
    s_lshl_b32 s74, s75, 1
    v_or_b32 v22, s74, v20
    v_lshl_or_b32 v23, v18, 1, v19
    v_lshlrev_b32 v23, 1, v23
    v_xor_b32 v22, v22, v23
    v_lshl_add_u32 v22, v22, 4, v17
    v_lshl_add_u32 v22, v21, 3, v22
    v_lshl_add_u32 v40, v18, 13, v22
    v_add_u32 v40, 0x2000, v40
    v_xor_b32 v41, 32, v40
    v_lshl_or_b32 v22, v18, 1, v21
    v_or_b32 v22, s74, v22
    v_lshlrev_b32 v23, 2, v19
    v_xor_b32 v22, v22, v23
    v_lshl_add_u32 v22, v22, 4, v17
    v_lshl_add_u32 v22, v20, 3, v22
    v_add_u32 v42, 0x6000, v22
    v_add_u32 v36, 0x10000, v32
    v_add_u32 v37, 0x10000, v33
    v_add_u32 v38, 0x10000, v34
    v_add_u32 v39, 0x10000, v35
    v_add_u32 v43, 0x10000, v40
    v_add_u32 v44, 0x10000, v41
    v_add_u32 v45, 0x10000, v42
    v_and_b32 v16, 15, v1
    v_lshlrev_b32 v16, 4, v16
    v_lshl_add_u32 v16, v15, 8, v16
    v_lshl_add_u32 v223, v18, 16, v16
    s_lshl_b32 s74, s7, 2
    s_add_u32 s74, s74, s75
    s_lshl_b32 s74, s74, 6
    s_lshl_b32 s76, s6, 1
    s_add_u32 s74, s74, s76
    s_add_u32 s74, s74, s73
    s_lshl_b32 s8, s74, 10
    s_lshl_b32 s73, s73, 8
    s_bitcmp1_b32 s66, 1
    s_mov_b32 s74, 0
    s_cselect_b32 s74, 14256, s74
    s_mov_b32 s75, 98304
    s_cselect_b32 s75, 115200, s75
    s_add_u32 s74, s74, s73
    s_add_u32 s75, s75, s73
    v_lshl_add_u32 v219, v1, 2, s74
    v_lshl_add_u32 v46, v1, 2, s75
    s_waitcnt vmcnt(8) lgkmcnt(0)
    s_add_u32 s67, s67, 1
    s_bitcmp1_b32 s66, 1
    s_cselect_b32 s73, 0, 16
    s_lshl_b32 s73, s68, s73
    s_and_b32 s73, s73, 0xffff0000
    v_mov_b32 v25, 0x3fb8aa3b
    v_mul_f32 v25, s73, v25
    v_exp_f32 v25, v25
    v_lshlrev_b32 v4, 16, v4
    v_lshlrev_b32 v5, 16, v5
    v_cvt_pk_bf16_f32 v25, v25, v25
    v_and_b32 v25, 0xffff0000, v25
    v_mul_f32 v220, v25, v4
    v_mul_f32 v221, v25, v5
    v_mul_f32 v220, 0x3fb8aa3b, v220
    v_mul_f32 v221, 0x3e22f983, v221
    v_mul_f32 v18, 0x41000000, v220
    v_mul_f32 v19, 0x41000000, v221
    v_fract_f32 v19, v19
    v_mul_f32 v20, 0x42800000, v220
    v_mul_f32 v21, 0x42800000, v221
    v_fract_f32 v21, v21
    v_exp_f32 v18, v18
    v_cos_f32 v50, v19
    v_sin_f32 v51, v19
    v_exp_f32 v20, v20
    v_cos_f32 v66, v21
    v_sin_f32 v67, v21
    s_nop 0
    v_pk_mul_f32 v[50:51], v[50:51], v[18:19] op_sel:[0,0] op_sel_hi:[1,0]
    v_pk_mul_f32 v[66:67], v[66:67], v[20:21] op_sel:[0,0] op_sel_hi:[1,0]
    v_mov_b32 v95, 0x3f80
    ds_write_b32 v46, v95
    v_pk_mul_f32 v[52:53], v[50:51], v[50:51] op_sel:[0,0] op_sel_hi:[1,0]
    v_pk_mul_f32 v[68:69], v[66:67], v[66:67] op_sel:[0,0] op_sel_hi:[1,0]
    v_pk_fma_f32 v[52:53], v[50:51], v[50:51], v[52:53] op_sel:[1,1,0] op_sel_hi:[0,1,1] neg_lo:[1,0,0]
    v_pk_fma_f32 v[68:69], v[66:67], v[66:67], v[68:69] op_sel:[1,1,0] op_sel_hi:[0,1,1] neg_lo:[1,0,0]
    v_cvt_pk_bf16_f32 v88, v50, v51
    ds_write_b32 v46, v88 offset:528
    v_cvt_pk_bf16_f32 v89, v66, v67
    ds_write_b32 v46, v89 offset:4224
    v_pk_mul_f32 v[54:55], v[52:53], v[50:51] op_sel:[0,0] op_sel_hi:[1,0]
    v_pk_mul_f32 v[56:57], v[52:53], v[52:53] op_sel:[0,0] op_sel_hi:[1,0]
    v_pk_mul_f32 v[70:71], v[68:69], v[66:67] op_sel:[0,0] op_sel_hi:[1,0]
    v_pk_fma_f32 v[54:55], v[52:53], v[50:51], v[54:55] op_sel:[1,1,0] op_sel_hi:[0,1,1] neg_lo:[1,0,0]
    v_pk_fma_f32 v[56:57], v[52:53], v[52:53], v[56:57] op_sel:[1,1,0] op_sel_hi:[0,1,1] neg_lo:[1,0,0]
    v_pk_fma_f32 v[70:71], v[68:69], v[66:67], v[70:71] op_sel:[1,1,0] op_sel_hi:[0,1,1] neg_lo:[1,0,0]
    v_cvt_pk_bf16_f32 v90, v52, v53
    ds_write_b32 v46, v90 offset:1056
    v_cvt_pk_bf16_f32 v91, v68, v69
    ds_write_b32 v46, v91 offset:8448
    v_pk_mul_f32 v[58:59], v[56:57], v[50:51] op_sel:[0,0] op_sel_hi:[1,0]
    v_pk_mul_f32 v[60:61], v[56:57], v[52:53] op_sel:[0,0] op_sel_hi:[1,0]
    v_pk_mul_f32 v[62:63], v[56:57], v[54:55] op_sel:[0,0] op_sel_hi:[1,0]
    v_pk_fma_f32 v[58:59], v[56:57], v[50:51], v[58:59] op_sel:[1,1,0] op_sel_hi:[0,1,1] neg_lo:[1,0,0]
    v_pk_fma_f32 v[60:61], v[56:57], v[52:53], v[60:61] op_sel:[1,1,0] op_sel_hi:[0,1,1] neg_lo:[1,0,0]
    v_pk_fma_f32 v[62:63], v[56:57], v[54:55], v[62:63] op_sel:[1,1,0] op_sel_hi:[0,1,1] neg_lo:[1,0,0]
    v_cvt_pk_bf16_f32 v92, v54, v55
    ds_write_b32 v46, v92 offset:1584
    v_cvt_pk_bf16_f32 v93, v56, v57
    ds_write_b32 v46, v93 offset:2112
    v_cvt_pk_bf16_f32 v94, v70, v71
    ds_write_b32 v46, v94 offset:12672
    v_cvt_pk_bf16_f32 v95, v58, v59
    ds_write_b32 v46, v95 offset:2640
    v_cvt_pk_bf16_f32 v88, v60, v61
    ds_write_b32 v46, v88 offset:3168
    v_cvt_pk_bf16_f32 v89, v62, v63
    ds_write_b32 v46, v89 offset:3696
    v_pk_mul_f32 v[74:75], v[50:51], v[66:67] op_sel:[0,0] op_sel_hi:[1,0]
    v_pk_mul_f32 v[76:77], v[52:53], v[66:67] op_sel:[0,0] op_sel_hi:[1,0]
    v_pk_mul_f32 v[78:79], v[54:55], v[66:67] op_sel:[0,0] op_sel_hi:[1,0]
    v_pk_mul_f32 v[80:81], v[56:57], v[66:67] op_sel:[0,0] op_sel_hi:[1,0]
    v_pk_mul_f32 v[82:83], v[58:59], v[66:67] op_sel:[0,0] op_sel_hi:[1,0]
    v_pk_mul_f32 v[84:85], v[60:61], v[66:67] op_sel:[0,0] op_sel_hi:[1,0]
    v_pk_mul_f32 v[86:87], v[62:63], v[66:67] op_sel:[0,0] op_sel_hi:[1,0]
    v_pk_fma_f32 v[74:75], v[50:51], v[66:67], v[74:75] op_sel:[1,1,0] op_sel_hi:[0,1,1] neg_lo:[1,0,0]
    v_pk_fma_f32 v[76:77], v[52:53], v[66:67], v[76:77] op_sel:[1,1,0] op_sel_hi:[0,1,1] neg_lo:[1,0,0]
    v_pk_fma_f32 v[78:79], v[54:55], v[66:67], v[78:79] op_sel:[1,1,0] op_sel_hi:[0,1,1] neg_lo:[1,0,0]
    v_pk_fma_f32 v[80:81], v[56:57], v[66:67], v[80:81] op_sel:[1,1,0] op_sel_hi:[0,1,1] neg_lo:[1,0,0]
    v_pk_fma_f32 v[82:83], v[58:59], v[66:67], v[82:83] op_sel:[1,1,0] op_sel_hi:[0,1,1] neg_lo:[1,0,0]
    v_pk_fma_f32 v[84:85], v[60:61], v[66:67], v[84:85] op_sel:[1,1,0] op_sel_hi:[0,1,1] neg_lo:[1,0,0]
    v_pk_fma_f32 v[86:87], v[62:63], v[66:67], v[86:87] op_sel:[1,1,0] op_sel_hi:[0,1,1] neg_lo:[1,0,0]
    v_cvt_pk_bf16_f32 v90, v74, v75
    ds_write_b32 v46, v90 offset:4752
    v_cvt_pk_bf16_f32 v91, v76, v77
    ds_write_b32 v46, v91 offset:5280
    v_cvt_pk_bf16_f32 v92, v78, v79
    ds_write_b32 v46, v92 offset:5808
    v_cvt_pk_bf16_f32 v93, v80, v81
    ds_write_b32 v46, v93 offset:6336
    v_cvt_pk_bf16_f32 v94, v82, v83
    ds_write_b32 v46, v94 offset:6864
    v_cvt_pk_bf16_f32 v95, v84, v85
    ds_write_b32 v46, v95 offset:7392
    v_cvt_pk_bf16_f32 v88, v86, v87
    ds_write_b32 v46, v88 offset:7920
    v_pk_mul_f32 v[74:75], v[50:51], v[68:69] op_sel:[0,0] op_sel_hi:[1,0]
    v_pk_mul_f32 v[76:77], v[52:53], v[68:69] op_sel:[0,0] op_sel_hi:[1,0]
    v_pk_mul_f32 v[78:79], v[54:55], v[68:69] op_sel:[0,0] op_sel_hi:[1,0]
    v_pk_mul_f32 v[80:81], v[56:57], v[68:69] op_sel:[0,0] op_sel_hi:[1,0]
    v_pk_mul_f32 v[82:83], v[58:59], v[68:69] op_sel:[0,0] op_sel_hi:[1,0]
    v_pk_mul_f32 v[84:85], v[60:61], v[68:69] op_sel:[0,0] op_sel_hi:[1,0]
    v_pk_mul_f32 v[86:87], v[62:63], v[68:69] op_sel:[0,0] op_sel_hi:[1,0]
    v_pk_fma_f32 v[74:75], v[50:51], v[68:69], v[74:75] op_sel:[1,1,0] op_sel_hi:[0,1,1] neg_lo:[1,0,0]
    v_pk_fma_f32 v[76:77], v[52:53], v[68:69], v[76:77] op_sel:[1,1,0] op_sel_hi:[0,1,1] neg_lo:[1,0,0]
    v_pk_fma_f32 v[78:79], v[54:55], v[68:69], v[78:79] op_sel:[1,1,0] op_sel_hi:[0,1,1] neg_lo:[1,0,0]
    v_pk_fma_f32 v[80:81], v[56:57], v[68:69], v[80:81] op_sel:[1,1,0] op_sel_hi:[0,1,1] neg_lo:[1,0,0]
    v_pk_fma_f32 v[82:83], v[58:59], v[68:69], v[82:83] op_sel:[1,1,0] op_sel_hi:[0,1,1] neg_lo:[1,0,0]
    v_pk_fma_f32 v[84:85], v[60:61], v[68:69], v[84:85] op_sel:[1,1,0] op_sel_hi:[0,1,1] neg_lo:[1,0,0]
    v_pk_fma_f32 v[86:87], v[62:63], v[68:69], v[86:87] op_sel:[1,1,0] op_sel_hi:[0,1,1] neg_lo:[1,0,0]
    v_cvt_pk_bf16_f32 v89, v74, v75
    ds_write_b32 v46, v89 offset:8976
    v_cvt_pk_bf16_f32 v90, v76, v77
    ds_write_b32 v46, v90 offset:9504
    v_cvt_pk_bf16_f32 v91, v78, v79
    ds_write_b32 v46, v91 offset:10032
    v_cvt_pk_bf16_f32 v92, v80, v81
    ds_write_b32 v46, v92 offset:10560
    v_cvt_pk_bf16_f32 v93, v82, v83
    ds_write_b32 v46, v93 offset:11088
    v_cvt_pk_bf16_f32 v94, v84, v85
    ds_write_b32 v46, v94 offset:11616
    v_cvt_pk_bf16_f32 v95, v86, v87
    ds_write_b32 v46, v95 offset:12144
    v_pk_mul_f32 v[74:75], v[50:51], v[70:71] op_sel:[0,0] op_sel_hi:[1,0]
    v_pk_mul_f32 v[76:77], v[52:53], v[70:71] op_sel:[0,0] op_sel_hi:[1,0]
    v_pk_mul_f32 v[78:79], v[54:55], v[70:71] op_sel:[0,0] op_sel_hi:[1,0]
    v_pk_mul_f32 v[80:81], v[56:57], v[70:71] op_sel:[0,0] op_sel_hi:[1,0]
    v_pk_mul_f32 v[82:83], v[58:59], v[70:71] op_sel:[0,0] op_sel_hi:[1,0]
    v_pk_mul_f32 v[84:85], v[60:61], v[70:71] op_sel:[0,0] op_sel_hi:[1,0]
    v_pk_mul_f32 v[86:87], v[62:63], v[70:71] op_sel:[0,0] op_sel_hi:[1,0]
    v_pk_fma_f32 v[74:75], v[50:51], v[70:71], v[74:75] op_sel:[1,1,0] op_sel_hi:[0,1,1] neg_lo:[1,0,0]
    v_pk_fma_f32 v[76:77], v[52:53], v[70:71], v[76:77] op_sel:[1,1,0] op_sel_hi:[0,1,1] neg_lo:[1,0,0]
    v_pk_fma_f32 v[78:79], v[54:55], v[70:71], v[78:79] op_sel:[1,1,0] op_sel_hi:[0,1,1] neg_lo:[1,0,0]
    v_pk_fma_f32 v[80:81], v[56:57], v[70:71], v[80:81] op_sel:[1,1,0] op_sel_hi:[0,1,1] neg_lo:[1,0,0]
    v_pk_fma_f32 v[82:83], v[58:59], v[70:71], v[82:83] op_sel:[1,1,0] op_sel_hi:[0,1,1] neg_lo:[1,0,0]
    v_pk_fma_f32 v[84:85], v[60:61], v[70:71], v[84:85] op_sel:[1,1,0] op_sel_hi:[0,1,1] neg_lo:[1,0,0]
    v_pk_fma_f32 v[86:87], v[62:63], v[70:71], v[86:87] op_sel:[1,1,0] op_sel_hi:[0,1,1] neg_lo:[1,0,0]
    v_cvt_pk_bf16_f32 v88, v74, v75
    ds_write_b32 v46, v88 offset:13200
    v_cvt_pk_bf16_f32 v89, v76, v77
    ds_write_b32 v46, v89 offset:13728
    v_cvt_pk_bf16_f32 v90, v78, v79
    ds_write_b32 v46, v90 offset:14256
    v_cvt_pk_bf16_f32 v91, v80, v81
    ds_write_b32 v46, v91 offset:14784
    v_cvt_pk_bf16_f32 v92, v82, v83
    ds_write_b32 v46, v92 offset:15312
    v_cvt_pk_bf16_f32 v93, v84, v85
    ds_write_b32 v46, v93 offset:15840
    v_cvt_pk_bf16_f32 v94, v86, v87
    ds_write_b32 v46, v94 offset:16368
    s_waitcnt vmcnt(4)
    v_mul_f32 v18, 0x3f800000, v220
    v_mul_f32 v19, 0xbf800000, v221
    v_fract_f32 v19, v19
    v_mul_f32 v20, 0x43800000, v220
    v_mul_f32 v21, 0xc3800000, v221
    v_fract_f32 v21, v21
    v_exp_f32 v18, v18
    v_cos_f32 v224, v19
    v_sin_f32 v225, v19
    v_exp_f32 v20, v20
    v_cos_f32 v178, v21
    v_sin_f32 v179, v21
    s_nop 0
    v_pk_mul_f32 v[224:225], v[224:225], v[18:19] op_sel:[0,0] op_sel_hi:[1,0]
    v_pk_mul_f32 v[178:179], v[178:179], v[20:21] op_sel:[0,0] op_sel_hi:[1,0]
    v_lshlrev_b32 v6, 16, v6
    v_lshlrev_b32 v7, 16, v7
    v_lshlrev_b32 v8, 16, v8
    v_lshlrev_b32 v9, 16, v9
    v_mul_f32 v18, v25, v6
    v_mul_f32 v19, -v25, v7
    v_mov_b32 v20, v8
    v_mul_f32 v21, -1.0, v9
    v_pk_mul_f32 v[160:161], v[18:19], v[20:21] op_sel:[0,0] op_sel_hi:[1,0]
    v_pk_mul_f32 v[226:227], v[224:225], v[224:225] op_sel:[0,0] op_sel_hi:[1,0]
    v_pk_mul_f32 v[180:181], v[178:179], v[178:179] op_sel:[0,0] op_sel_hi:[1,0]
    v_pk_fma_f32 v[160:161], v[18:19], v[20:21], v[160:161] op_sel:[1,1,0] op_sel_hi:[0,1,1] neg_lo:[1,0,0]
    v_pk_fma_f32 v[226:227], v[224:225], v[224:225], v[226:227] op_sel:[1,1,0] op_sel_hi:[0,1,1] neg_lo:[1,0,0]
    v_pk_fma_f32 v[180:181], v[178:179], v[178:179], v[180:181] op_sel:[1,1,0] op_sel_hi:[0,1,1] neg_lo:[1,0,0]
    v_pk_mul_f32 v[228:229], v[226:227], v[224:225] op_sel:[0,0] op_sel_hi:[1,0]
    v_pk_mul_f32 v[230:231], v[226:227], v[226:227] op_sel:[0,0] op_sel_hi:[1,0]
    v_pk_mul_f32 v[182:183], v[180:181], v[178:179] op_sel:[0,0] op_sel_hi:[1,0]
    v_pk_mul_f32 v[184:185], v[180:181], v[180:181] op_sel:[0,0] op_sel_hi:[1,0]
    v_pk_fma_f32 v[228:229], v[226:227], v[224:225], v[228:229] op_sel:[1,1,0] op_sel_hi:[0,1,1] neg_lo:[1,0,0]
    v_pk_fma_f32 v[230:231], v[226:227], v[226:227], v[230:231] op_sel:[1,1,0] op_sel_hi:[0,1,1] neg_lo:[1,0,0]
    v_pk_fma_f32 v[182:183], v[180:181], v[178:179], v[182:183] op_sel:[1,1,0] op_sel_hi:[0,1,1] neg_lo:[1,0,0]
    v_pk_fma_f32 v[184:185], v[180:181], v[180:181], v[184:185] op_sel:[1,1,0] op_sel_hi:[0,1,1] neg_lo:[1,0,0]
    v_cvt_pk_bf16_f32 v192, v160, v161
    v_pk_mul_f32 v[232:233], v[230:231], v[224:225] op_sel:[0,0] op_sel_hi:[1,0]
    v_pk_mul_f32 v[234:235], v[230:231], v[226:227] op_sel:[0,0] op_sel_hi:[1,0]
    v_pk_mul_f32 v[236:237], v[230:231], v[228:229] op_sel:[0,0] op_sel_hi:[1,0]
    v_pk_mul_f32 v[238:239], v[230:231], v[230:231] op_sel:[0,0] op_sel_hi:[1,0]
    v_pk_mul_f32 v[186:187], v[184:185], v[178:179] op_sel:[0,0] op_sel_hi:[1,0]
    v_pk_mul_f32 v[188:189], v[184:185], v[180:181] op_sel:[0,0] op_sel_hi:[1,0]
    v_pk_mul_f32 v[190:191], v[184:185], v[182:183] op_sel:[0,0] op_sel_hi:[1,0]
    s_barrier
    ds_read_b128 v[96:99], v32 offset:0
    ds_read_b64_tr_b16 v[112:113], v40 offset:0
    ds_read_b64_tr_b16 v[114:115], v40 offset:512
    ds_read_b64_tr_b16 v[128:129], v41 offset:0
    ds_read_b64_tr_b16 v[130:131], v41 offset:512
    ds_read_b64_tr_b16 v[144:145], v42 offset:0
    ds_read_b64_tr_b16 v[146:147], v42 offset:512
    ds_read_b128 v[100:103], v33 offset:0
    ds_read_b64_tr_b16 v[116:117], v40 offset:2048
    ds_read_b64_tr_b16 v[118:119], v40 offset:2560
    ds_read_b64_tr_b16 v[132:133], v41 offset:2048
    ds_read_b64_tr_b16 v[134:135], v41 offset:2560
    ds_read_b64_tr_b16 v[148:149], v42 offset:2048
    ds_read_b64_tr_b16 v[150:151], v42 offset:2560
    s_waitcnt lgkmcnt(7)
    v_mfma_f32_32x32x16_bf16 v[48:63], v[112:115], v[96:99], 0
    ds_read_b128 v[104:107], v34 offset:0
    ds_read_b64_tr_b16 v[120:121], v40 offset:4096
    ds_read_b64_tr_b16 v[122:123], v40 offset:4608
    v_mfma_f32_32x32x16_bf16 v[64:79], v[128:131], v[96:99], 0
    ds_read_b64_tr_b16 v[136:137], v41 offset:4096
    ds_read_b64_tr_b16 v[138:139], v41 offset:4608
    v_mfma_f32_32x32x16_bf16 v[80:95], v[96:99], v[144:147], 0
    ds_read_b64_tr_b16 v[152:153], v42 offset:4096
    ds_read_b64_tr_b16 v[154:155], v42 offset:4608
    s_waitcnt lgkmcnt(7)
    v_mfma_f32_32x32x16_bf16 v[48:63], v[116:119], v[100:103], v[48:63]
    ds_read_b128 v[108:111], v35 offset:0
    ds_read_b64_tr_b16 v[124:125], v40 offset:6144
    ds_read_b64_tr_b16 v[126:127], v40 offset:6656
    v_mfma_f32_32x32x16_bf16 v[64:79], v[132:135], v[100:103], v[64:79]
    ds_read_b64_tr_b16 v[140:141], v41 offset:6144
    ds_read_b64_tr_b16 v[142:143], v41 offset:6656
    v_mfma_f32_32x32x16_bf16 v[80:95], v[100:103], v[148:151], v[80:95]
    ds_read_b64_tr_b16 v[156:157], v42 offset:6144
    ds_read_b64_tr_b16 v[158:159], v42 offset:6656
    s_waitcnt lgkmcnt(7)
    v_mfma_f32_32x32x16_bf16 v[48:63], v[120:123], v[104:107], v[48:63]
    s_waitcnt vmcnt(0)
    v_mov_b32 v240, v196
    v_mov_b32 v241, v200
    v_mov_b32 v242, v204
    v_mov_b32 v243, v208
    v_mov_b32 v244, v197
    v_mfma_f32_32x32x16_bf16 v[64:79], v[136:139], v[104:107], v[64:79]
    v_mov_b32 v245, v201
    v_mov_b32 v246, v205
    v_mov_b32 v247, v209
    v_mov_b32 v248, v198
    v_mov_b32 v249, v202
    v_mov_b32 v250, v206
    v_mfma_f32_32x32x16_bf16 v[80:95], v[104:107], v[152:155], v[80:95]
    v_mov_b32 v251, v210
    v_mov_b32 v252, v199
    v_mov_b32 v253, v203
    v_mov_b32 v254, v207
    v_mov_b32 v255, v211
    s_waitcnt lgkmcnt(0)
    s_barrier
    ds_read_b128 v[96:99], v32 offset:32768
    ds_read_b64_tr_b16 v[112:113], v40 offset:32768
    ds_read_b64_tr_b16 v[114:115], v40 offset:33280
    v_mfma_f32_32x32x16_bf16 v[48:63], v[124:127], v[108:111], v[48:63]
    ds_read_b64_tr_b16 v[128:129], v41 offset:32768
    ds_read_b64_tr_b16 v[130:131], v41 offset:33280
    ds_read_b64_tr_b16 v[144:145], v42 offset:32768
    v_mfma_f32_32x32x16_bf16 v[64:79], v[140:143], v[108:111], v[64:79]
    ds_read_b64_tr_b16 v[146:147], v42 offset:33280
    ds_read_b128 v[100:103], v33 offset:32768
    ds_read_b64_tr_b16 v[116:117], v40 offset:34816
    v_mfma_f32_32x32x16_bf16 v[80:95], v[108:111], v[156:159], v[80:95]
    ds_read_b64_tr_b16 v[118:119], v40 offset:35328
    ds_read_b64_tr_b16 v[132:133], v41 offset:34816
    ds_read_b64_tr_b16 v[134:135], v41 offset:35328
    ds_read_b64_tr_b16 v[148:149], v42 offset:34816
    ds_read_b64_tr_b16 v[150:151], v42 offset:35328
    s_lshl_b32 s20, s64, 18
    s_add_u32 s20, s20, 0x900000
    s_mov_b32 exec_hi, 0
    buffer_store_dwordx4 v[240:243], v31, s[48:51], s20 offen sc1
    s_add_u32 s20, s20, 0x2000
    buffer_store_dwordx4 v[244:247], v31, s[48:51], s20 offen sc1
    s_add_u32 s20, s20, 0x2000
    buffer_store_dwordx4 v[248:251], v31, s[48:51], s20 offen sc1
    s_add_u32 s20, s20, 0x2000
    buffer_store_dwordx4 v[252:255], v31, s[48:51], s20 offen sc1
    s_mov_b32 exec_hi, -1
    v_pk_fma_f32 v[232:233], v[230:231], v[224:225], v[232:233] op_sel:[1,1,0] op_sel_hi:[0,1,1] neg_lo:[1,0,0]
    v_pk_fma_f32 v[234:235], v[230:231], v[226:227], v[234:235] op_sel:[1,1,0] op_sel_hi:[0,1,1] neg_lo:[1,0,0]
    v_pk_fma_f32 v[236:237], v[230:231], v[228:229], v[236:237] op_sel:[1,1,0] op_sel_hi:[0,1,1] neg_lo:[1,0,0]
    v_pk_fma_f32 v[238:239], v[230:231], v[230:231], v[238:239] op_sel:[1,1,0] op_sel_hi:[0,1,1] neg_lo:[1,0,0]
    v_pk_fma_f32 v[186:187], v[184:185], v[178:179], v[186:187] op_sel:[1,1,0] op_sel_hi:[0,1,1] neg_lo:[1,0,0]
    s_waitcnt lgkmcnt(7)
    v_mfma_f32_32x32x16_bf16 v[48:63], v[112:115], v[96:99], v[48:63]
    ds_read_b128 v[104:107], v34 offset:32768
    ds_read_b64_tr_b16 v[120:121], v40 offset:36864
    ds_read_b64_tr_b16 v[122:123], v40 offset:37376
    v_pk_fma_f32 v[188:189], v[184:185], v[180:181], v[188:189] op_sel:[1,1,0] op_sel_hi:[0,1,1] neg_lo:[1,0,0]
    v_mfma_f32_32x32x16_bf16 v[64:79], v[128:131], v[96:99], v[64:79]
    ds_read_b64_tr_b16 v[136:137], v41 offset:36864
    ds_read_b64_tr_b16 v[138:139], v41 offset:37376
    v_pk_fma_f32 v[190:191], v[184:185], v[182:183], v[190:191] op_sel:[1,1,0] op_sel_hi:[0,1,1] neg_lo:[1,0,0]
    v_mfma_f32_32x32x16_bf16 v[80:95], v[96:99], v[144:147], v[80:95]
    ds_read_b64_tr_b16 v[152:153], v42 offset:36864
    ds_read_b64_tr_b16 v[154:155], v42 offset:37376
    v_pk_mul_f32 v[162:163], v[160:161], v[224:225] op_sel:[0,0] op_sel_hi:[1,0]
    s_waitcnt lgkmcnt(7)
    v_mfma_f32_32x32x16_bf16 v[48:63], v[116:119], v[100:103], v[48:63]
    ds_read_b128 v[108:111], v35 offset:32768
    ds_read_b64_tr_b16 v[124:125], v40 offset:38912
    ds_read_b64_tr_b16 v[126:127], v40 offset:39424
    v_pk_mul_f32 v[164:165], v[160:161], v[226:227] op_sel:[0,0] op_sel_hi:[1,0]
    v_mfma_f32_32x32x16_bf16 v[64:79], v[132:135], v[100:103], v[64:79]
    ds_read_b64_tr_b16 v[140:141], v41 offset:38912
    ds_read_b64_tr_b16 v[142:143], v41 offset:39424
    v_pk_mul_f32 v[166:167], v[160:161], v[228:229] op_sel:[0,0] op_sel_hi:[1,0]
    v_mfma_f32_32x32x16_bf16 v[80:95], v[100:103], v[148:151], v[80:95]
    ds_read_b64_tr_b16 v[156:157], v42 offset:38912
    ds_read_b64_tr_b16 v[158:159], v42 offset:39424
    v_pk_mul_f32 v[168:169], v[160:161], v[230:231] op_sel:[0,0] op_sel_hi:[1,0]
    s_waitcnt lgkmcnt(7)
    v_mfma_f32_32x32x16_bf16 v[48:63], v[120:123], v[104:107], v[48:63]
    v_pk_mul_f32 v[170:171], v[160:161], v[232:233] op_sel:[0,0] op_sel_hi:[1,0]
    v_pk_mul_f32 v[172:173], v[160:161], v[234:235] op_sel:[0,0] op_sel_hi:[1,0]
    v_mfma_f32_32x32x16_bf16 v[64:79], v[136:139], v[104:107], v[64:79]
    v_pk_mul_f32 v[174:175], v[160:161], v[236:237] op_sel:[0,0] op_sel_hi:[1,0]
    v_pk_mul_f32 v[176:177], v[160:161], v[238:239] op_sel:[0,0] op_sel_hi:[1,0]
    v_mfma_f32_32x32x16_bf16 v[80:95], v[104:107], v[152:155], v[80:95]
    v_pk_fma_f32 v[162:163], v[160:161], v[224:225], v[162:163] op_sel:[1,1,0] op_sel_hi:[0,1,1] neg_lo:[1,0,0]
    v_pk_fma_f32 v[164:165], v[160:161], v[226:227], v[164:165] op_sel:[1,1,0] op_sel_hi:[0,1,1] neg_lo:[1,0,0]
    s_waitcnt lgkmcnt(0)
    s_barrier
    ds_read_b128 v[96:99], v36 offset:0
    ds_read_b64_tr_b16 v[112:113], v43 offset:0
    ds_read_b64_tr_b16 v[114:115], v43 offset:512
    v_mfma_f32_32x32x16_bf16 v[48:63], v[124:127], v[108:111], v[48:63]
    ds_read_b64_tr_b16 v[128:129], v44 offset:0
    ds_read_b64_tr_b16 v[130:131], v44 offset:512
    ds_read_b64_tr_b16 v[144:145], v45 offset:0
    v_mfma_f32_32x32x16_bf16 v[64:79], v[140:143], v[108:111], v[64:79]
    ds_read_b64_tr_b16 v[146:147], v45 offset:512
    ds_read_b128 v[100:103], v37 offset:0
    ds_read_b64_tr_b16 v[116:117], v43 offset:2048
    v_mfma_f32_32x32x16_bf16 v[80:95], v[108:111], v[156:159], v[80:95]
    ds_read_b64_tr_b16 v[118:119], v43 offset:2560
    ds_read_b64_tr_b16 v[132:133], v44 offset:2048
    ds_read_b64_tr_b16 v[134:135], v44 offset:2560
    ds_read_b64_tr_b16 v[148:149], v45 offset:2048
    ds_read_b64_tr_b16 v[150:151], v45 offset:2560
    v_pk_fma_f32 v[166:167], v[160:161], v[228:229], v[166:167] op_sel:[1,1,0] op_sel_hi:[0,1,1] neg_lo:[1,0,0]
    v_pk_fma_f32 v[168:169], v[160:161], v[230:231], v[168:169] op_sel:[1,1,0] op_sel_hi:[0,1,1] neg_lo:[1,0,0]
    v_pk_fma_f32 v[170:171], v[160:161], v[232:233], v[170:171] op_sel:[1,1,0] op_sel_hi:[0,1,1] neg_lo:[1,0,0]
    v_pk_fma_f32 v[172:173], v[160:161], v[234:235], v[172:173] op_sel:[1,1,0] op_sel_hi:[0,1,1] neg_lo:[1,0,0]
    v_pk_fma_f32 v[174:175], v[160:161], v[236:237], v[174:175] op_sel:[1,1,0] op_sel_hi:[0,1,1] neg_lo:[1,0,0]
    s_waitcnt lgkmcnt(7)
    v_mfma_f32_32x32x16_bf16 v[48:63], v[112:115], v[96:99], v[48:63]
    ds_read_b128 v[104:107], v38 offset:0
    ds_read_b64_tr_b16 v[120:121], v43 offset:4096
    ds_read_b64_tr_b16 v[122:123], v43 offset:4608
    v_pk_fma_f32 v[176:177], v[160:161], v[238:239], v[176:177] op_sel:[1,1,0] op_sel_hi:[0,1,1] neg_lo:[1,0,0]
    v_mfma_f32_32x32x16_bf16 v[64:79], v[128:131], v[96:99], v[64:79]
    ds_read_b64_tr_b16 v[136:137], v44 offset:4096
    ds_read_b64_tr_b16 v[138:139], v44 offset:4608
    v_cvt_pk_bf16_f32 v193, v162, v163
    v_mfma_f32_32x32x16_bf16 v[80:95], v[96:99], v[144:147], v[80:95]
    ds_read_b64_tr_b16 v[152:153], v45 offset:4096
    ds_read_b64_tr_b16 v[154:155], v45 offset:4608
    v_cvt_pk_bf16_f32 v194, v164, v165
    s_waitcnt lgkmcnt(7)
    v_mfma_f32_32x32x16_bf16 v[48:63], v[116:119], v[100:103], v[48:63]
    ds_read_b128 v[108:111], v39 offset:0
    ds_read_b64_tr_b16 v[124:125], v43 offset:6144
    ds_read_b64_tr_b16 v[126:127], v43 offset:6656
    v_cvt_pk_bf16_f32 v195, v166, v167
    v_mfma_f32_32x32x16_bf16 v[64:79], v[132:135], v[100:103], v[64:79]
    ds_read_b64_tr_b16 v[140:141], v44 offset:6144
    ds_read_b64_tr_b16 v[142:143], v44 offset:6656
    v_cvt_pk_bf16_f32 v196, v168, v169
    v_mfma_f32_32x32x16_bf16 v[80:95], v[100:103], v[148:151], v[80:95]
    ds_read_b64_tr_b16 v[156:157], v45 offset:6144
    ds_read_b64_tr_b16 v[158:159], v45 offset:6656
    v_cvt_pk_bf16_f32 v197, v170, v171
    s_waitcnt lgkmcnt(7)
    v_mfma_f32_32x32x16_bf16 v[48:63], v[120:123], v[104:107], v[48:63]
    v_cvt_pk_bf16_f32 v198, v172, v173
    v_cvt_pk_bf16_f32 v199, v174, v175
    v_mfma_f32_32x32x16_bf16 v[64:79], v[136:139], v[104:107], v[64:79]
    v_pk_mul_f32 v[224:225], v[178:179], v[160:161] op_sel:[0,0] op_sel_hi:[1,0]
    v_pk_mul_f32 v[226:227], v[178:179], v[164:165] op_sel:[0,0] op_sel_hi:[1,0]
    v_mfma_f32_32x32x16_bf16 v[80:95], v[104:107], v[152:155], v[80:95]
    v_pk_mul_f32 v[228:229], v[178:179], v[168:169] op_sel:[0,0] op_sel_hi:[1,0]
    v_pk_mul_f32 v[230:231], v[178:179], v[172:173] op_sel:[0,0] op_sel_hi:[1,0]
    s_waitcnt lgkmcnt(0)
    s_barrier
    ds_read_b128 v[96:99], v32 offset:0
    ds_read_b64_tr_b16 v[112:113], v40 offset:0
    ds_read_b64_tr_b16 v[114:115], v40 offset:512
    v_mfma_f32_32x32x16_bf16 v[48:63], v[124:127], v[108:111], v[48:63]
    ds_read_b64_tr_b16 v[128:129], v41 offset:0
    ds_read_b64_tr_b16 v[130:131], v41 offset:512
    ds_read_b64_tr_b16 v[144:145], v42 offset:0
    v_mfma_f32_32x32x16_bf16 v[64:79], v[140:143], v[108:111], v[64:79]
    ds_read_b64_tr_b16 v[146:147], v42 offset:512
    ds_read_b128 v[100:103], v33 offset:0
    ds_read_b64_tr_b16 v[116:117], v40 offset:2048
    v_mfma_f32_32x32x16_bf16 v[80:95], v[108:111], v[156:159], v[80:95]
    ds_read_b64_tr_b16 v[118:119], v40 offset:2560
    ds_read_b64_tr_b16 v[132:133], v41 offset:2048
    ds_read_b64_tr_b16 v[134:135], v41 offset:2560
    ds_read_b64_tr_b16 v[148:149], v42 offset:2048
    ds_read_b64_tr_b16 v[150:151], v42 offset:2560
    v_pk_mul_f32 v[232:233], v[178:179], v[176:177] op_sel:[0,0] op_sel_hi:[1,0]
    v_pk_mul_f32 v[234:235], v[180:181], v[160:161] op_sel:[0,0] op_sel_hi:[1,0]
    v_pk_mul_f32 v[236:237], v[180:181], v[168:169] op_sel:[0,0] op_sel_hi:[1,0]
    v_pk_mul_f32 v[238:239], v[180:181], v[176:177] op_sel:[0,0] op_sel_hi:[1,0]
    v_pk_fma_f32 v[224:225], v[178:179], v[160:161], v[224:225] op_sel:[1,1,0] op_sel_hi:[0,1,1] neg_lo:[1,0,0]
    s_waitcnt lgkmcnt(7)
    v_mfma_f32_32x32x16_bf16 v[48:63], v[112:115], v[96:99], v[48:63]
    ds_read_b128 v[104:107], v34 offset:0
    ds_read_b64_tr_b16 v[120:121], v40 offset:4096
    ds_read_b64_tr_b16 v[122:123], v40 offset:4608
    v_pk_fma_f32 v[226:227], v[178:179], v[164:165], v[226:227] op_sel:[1,1,0] op_sel_hi:[0,1,1] neg_lo:[1,0,0]
    v_mfma_f32_32x32x16_bf16 v[64:79], v[128:131], v[96:99], v[64:79]
    ds_read_b64_tr_b16 v[136:137], v41 offset:4096
    ds_read_b64_tr_b16 v[138:139], v41 offset:4608
    v_pk_fma_f32 v[228:229], v[178:179], v[168:169], v[228:229] op_sel:[1,1,0] op_sel_hi:[0,1,1] neg_lo:[1,0,0]
    v_mfma_f32_32x32x16_bf16 v[80:95], v[96:99], v[144:147], v[80:95]
    ds_read_b64_tr_b16 v[152:153], v42 offset:4096
    ds_read_b64_tr_b16 v[154:155], v42 offset:4608
    v_pk_fma_f32 v[230:231], v[178:179], v[172:173], v[230:231] op_sel:[1,1,0] op_sel_hi:[0,1,1] neg_lo:[1,0,0]
    s_waitcnt lgkmcnt(7)
    v_mfma_f32_32x32x16_bf16 v[48:63], v[116:119], v[100:103], v[48:63]
    ds_read_b128 v[108:111], v35 offset:0
    ds_read_b64_tr_b16 v[124:125], v40 offset:6144
    ds_read_b64_tr_b16 v[126:127], v40 offset:6656
    v_pk_fma_f32 v[232:233], v[178:179], v[176:177], v[232:233] op_sel:[1,1,0] op_sel_hi:[0,1,1] neg_lo:[1,0,0]
    v_mfma_f32_32x32x16_bf16 v[64:79], v[132:135], v[100:103], v[64:79]
    ds_read_b64_tr_b16 v[140:141], v41 offset:6144
    ds_read_b64_tr_b16 v[142:143], v41 offset:6656
    v_pk_fma_f32 v[234:235], v[180:181], v[160:161], v[234:235] op_sel:[1,1,0] op_sel_hi:[0,1,1] neg_lo:[1,0,0]
    v_mfma_f32_32x32x16_bf16 v[80:95], v[100:103], v[148:151], v[80:95]
    ds_read_b64_tr_b16 v[156:157], v42 offset:6144
    ds_read_b64_tr_b16 v[158:159], v42 offset:6656
    v_pk_fma_f32 v[236:237], v[180:181], v[168:169], v[236:237] op_sel:[1,1,0] op_sel_hi:[0,1,1] neg_lo:[1,0,0]
    s_waitcnt lgkmcnt(7)
    v_mfma_f32_32x32x16_bf16 v[48:63], v[120:123], v[104:107], v[48:63]
    v_pk_fma_f32 v[238:239], v[180:181], v[176:177], v[238:239] op_sel:[1,1,0] op_sel_hi:[0,1,1] neg_lo:[1,0,0]
    v_cvt_pk_bf16_f32 v200, v224, v225
    v_mfma_f32_32x32x16_bf16 v[64:79], v[136:139], v[104:107], v[64:79]
    v_cvt_pk_bf16_f32 v201, v226, v227
    v_cvt_pk_bf16_f32 v202, v228, v229
    v_mfma_f32_32x32x16_bf16 v[80:95], v[104:107], v[152:155], v[80:95]
    v_cvt_pk_bf16_f32 v203, v230, v231
    v_cvt_pk_bf16_f32 v204, v232, v233
    s_waitcnt lgkmcnt(0)
    s_waitcnt vmcnt(0)
    s_barrier
    s_lshl_b32 s20, s64, 5
    s_add_u32 s20, s20, s65
    s_lshl_b32 s20, s20, 7
    s_add_u32 s20, s20, 0x20000
    v_mov_b32 v26, 0
    v_mov_b32 v27, s67
    s_mov_b64 exec, 1
    buffer_store_dword v27, v26, s[48:51], s20 offen sc1
    s_mov_b64 exec, -1
    ds_read_b128 v[96:99], v32 offset:32768
    ds_read_b64_tr_b16 v[112:113], v40 offset:32768
    ds_read_b64_tr_b16 v[114:115], v40 offset:33280
    v_mfma_f32_32x32x16_bf16 v[48:63], v[124:127], v[108:111], v[48:63]
    ds_read_b64_tr_b16 v[128:129], v41 offset:32768
    ds_read_b64_tr_b16 v[130:131], v41 offset:33280
    ds_read_b64_tr_b16 v[144:145], v42 offset:32768
    v_mfma_f32_32x32x16_bf16 v[64:79], v[140:143], v[108:111], v[64:79]
    ds_read_b64_tr_b16 v[146:147], v42 offset:33280
    ds_read_b128 v[100:103], v33 offset:32768
    ds_read_b64_tr_b16 v[116:117], v40 offset:34816
    v_mfma_f32_32x32x16_bf16 v[80:95], v[108:111], v[156:159], v[80:95]
    ds_read_b64_tr_b16 v[118:119], v40 offset:35328
    ds_read_b64_tr_b16 v[132:133], v41 offset:34816
    ds_read_b64_tr_b16 v[134:135], v41 offset:35328
    ds_read_b64_tr_b16 v[148:149], v42 offset:34816
    ds_read_b64_tr_b16 v[150:151], v42 offset:35328
    v_cvt_pk_bf16_f32 v205, v234, v235
    v_cvt_pk_bf16_f32 v206, v236, v237
    v_cvt_pk_bf16_f32 v207, v238, v239
    v_pk_mul_f32 v[224:225], v[182:183], v[160:161] op_sel:[0,0] op_sel_hi:[1,0]
    v_pk_mul_f32 v[226:227], v[182:183], v[168:169] op_sel:[0,0] op_sel_hi:[1,0]
    s_waitcnt lgkmcnt(7)
    v_mfma_f32_32x32x16_bf16 v[48:63], v[112:115], v[96:99], v[48:63]
    ds_read_b128 v[104:107], v34 offset:32768
    ds_read_b64_tr_b16 v[120:121], v40 offset:36864
    ds_read_b64_tr_b16 v[122:123], v40 offset:37376
    v_pk_mul_f32 v[228:229], v[182:183], v[176:177] op_sel:[0,0] op_sel_hi:[1,0]
    v_mfma_f32_32x32x16_bf16 v[64:79], v[128:131], v[96:99], v[64:79]
    ds_read_b64_tr_b16 v[136:137], v41 offset:36864
    ds_read_b64_tr_b16 v[138:139], v41 offset:37376
    v_pk_mul_f32 v[230:231], v[184:185], v[160:161] op_sel:[0,0] op_sel_hi:[1,0]
    v_mfma_f32_32x32x16_bf16 v[80:95], v[96:99], v[144:147], v[80:95]
    ds_read_b64_tr_b16 v[152:153], v42 offset:36864
    ds_read_b64_tr_b16 v[154:155], v42 offset:37376
    v_pk_mul_f32 v[232:233], v[184:185], v[176:177] op_sel:[0,0] op_sel_hi:[1,0]
    s_waitcnt lgkmcnt(7)
    v_mfma_f32_32x32x16_bf16 v[48:63], v[116:119], v[100:103], v[48:63]
    ds_read_b128 v[108:111], v35 offset:32768
    ds_read_b64_tr_b16 v[124:125], v40 offset:38912
    ds_read_b64_tr_b16 v[126:127], v40 offset:39424
    v_pk_mul_f32 v[234:235], v[186:187], v[160:161] op_sel:[0,0] op_sel_hi:[1,0]
    v_mfma_f32_32x32x16_bf16 v[64:79], v[132:135], v[100:103], v[64:79]
    ds_read_b64_tr_b16 v[140:141], v41 offset:38912
    ds_read_b64_tr_b16 v[142:143], v41 offset:39424
    v_pk_mul_f32 v[236:237], v[186:187], v[176:177] op_sel:[0,0] op_sel_hi:[1,0]
    v_mfma_f32_32x32x16_bf16 v[80:95], v[100:103], v[148:151], v[80:95]
    ds_read_b64_tr_b16 v[156:157], v42 offset:38912
    ds_read_b64_tr_b16 v[158:159], v42 offset:39424
    v_pk_fma_f32 v[224:225], v[182:183], v[160:161], v[224:225] op_sel:[1,1,0] op_sel_hi:[0,1,1] neg_lo:[1,0,0]
    s_waitcnt lgkmcnt(7)
    v_mfma_f32_32x32x16_bf16 v[48:63], v[120:123], v[104:107], v[48:63]
    v_pk_fma_f32 v[226:227], v[182:183], v[168:169], v[226:227] op_sel:[1,1,0] op_sel_hi:[0,1,1] neg_lo:[1,0,0]
    v_pk_fma_f32 v[228:229], v[182:183], v[176:177], v[228:229] op_sel:[1,1,0] op_sel_hi:[0,1,1] neg_lo:[1,0,0]
    v_mfma_f32_32x32x16_bf16 v[64:79], v[136:139], v[104:107], v[64:79]
    v_pk_fma_f32 v[230:231], v[184:185], v[160:161], v[230:231] op_sel:[1,1,0] op_sel_hi:[0,1,1] neg_lo:[1,0,0]
    v_pk_fma_f32 v[232:233], v[184:185], v[176:177], v[232:233] op_sel:[1,1,0] op_sel_hi:[0,1,1] neg_lo:[1,0,0]
    v_mfma_f32_32x32x16_bf16 v[80:95], v[104:107], v[152:155], v[80:95]
    v_pk_fma_f32 v[234:235], v[186:187], v[160:161], v[234:235] op_sel:[1,1,0] op_sel_hi:[0,1,1] neg_lo:[1,0,0]
    v_pk_fma_f32 v[236:237], v[186:187], v[176:177], v[236:237] op_sel:[1,1,0] op_sel_hi:[0,1,1] neg_lo:[1,0,0]
    s_waitcnt lgkmcnt(0)
    s_barrier
    ds_read_b128 v[96:99], v36 offset:0
    ds_read_b64_tr_b16 v[112:113], v43 offset:0
    ds_read_b64_tr_b16 v[114:115], v43 offset:512
    v_mfma_f32_32x32x16_bf16 v[48:63], v[124:127], v[108:111], v[48:63]
    ds_read_b64_tr_b16 v[128:129], v44 offset:0
    ds_read_b64_tr_b16 v[130:131], v44 offset:512
    ds_read_b64_tr_b16 v[144:145], v45 offset:0
    v_mfma_f32_32x32x16_bf16 v[64:79], v[140:143], v[108:111], v[64:79]
    ds_read_b64_tr_b16 v[146:147], v45 offset:512
    ds_read_b128 v[100:103], v37 offset:0
    ds_read_b64_tr_b16 v[116:117], v43 offset:2048
    v_mfma_f32_32x32x16_bf16 v[80:95], v[108:111], v[156:159], v[80:95]
    ds_read_b64_tr_b16 v[118:119], v43 offset:2560
    ds_read_b64_tr_b16 v[132:133], v44 offset:2048
    ds_read_b64_tr_b16 v[134:135], v44 offset:2560
    ds_read_b64_tr_b16 v[148:149], v45 offset:2048
    ds_read_b64_tr_b16 v[150:151], v45 offset:2560
    v_cvt_pk_bf16_f32 v208, v224, v225
    v_cvt_pk_bf16_f32 v209, v226, v227
    v_cvt_pk_bf16_f32 v210, v228, v229
    v_cvt_pk_bf16_f32 v211, v230, v231
    v_cvt_pk_bf16_f32 v212, v232, v233
    s_waitcnt lgkmcnt(7)
    v_mfma_f32_32x32x16_bf16 v[48:63], v[112:115], v[96:99], v[48:63]
    ds_read_b128 v[104:107], v38 offset:0
    ds_read_b64_tr_b16 v[120:121], v43 offset:4096
    ds_read_b64_tr_b16 v[122:123], v43 offset:4608
    v_cvt_pk_bf16_f32 v213, v234, v235
    v_mfma_f32_32x32x16_bf16 v[64:79], v[128:131], v[96:99], v[64:79]
    ds_read_b64_tr_b16 v[136:137], v44 offset:4096
    ds_read_b64_tr_b16 v[138:139], v44 offset:4608
    v_cvt_pk_bf16_f32 v214, v236, v237
    v_mfma_f32_32x32x16_bf16 v[80:95], v[96:99], v[144:147], v[80:95]
    ds_read_b64_tr_b16 v[152:153], v45 offset:4096
    ds_read_b64_tr_b16 v[154:155], v45 offset:4608
    v_pk_mul_f32 v[224:225], v[188:189], v[160:161] op_sel:[0,0] op_sel_hi:[1,0]
    s_waitcnt lgkmcnt(7)
    v_mfma_f32_32x32x16_bf16 v[48:63], v[116:119], v[100:103], v[48:63]
    ds_read_b128 v[108:111], v39 offset:0
    ds_read_b64_tr_b16 v[124:125], v43 offset:6144
    ds_read_b64_tr_b16 v[126:127], v43 offset:6656
    v_pk_mul_f32 v[226:227], v[188:189], v[176:177] op_sel:[0,0] op_sel_hi:[1,0]
    v_mfma_f32_32x32x16_bf16 v[64:79], v[132:135], v[100:103], v[64:79]
    ds_read_b64_tr_b16 v[140:141], v44 offset:6144
    ds_read_b64_tr_b16 v[142:143], v44 offset:6656
    v_pk_mul_f32 v[228:229], v[190:191], v[160:161] op_sel:[0,0] op_sel_hi:[1,0]
    v_mfma_f32_32x32x16_bf16 v[80:95], v[100:103], v[148:151], v[80:95]
    ds_read_b64_tr_b16 v[156:157], v45 offset:6144
    ds_read_b64_tr_b16 v[158:159], v45 offset:6656
    v_pk_mul_f32 v[230:231], v[190:191], v[176:177] op_sel:[0,0] op_sel_hi:[1,0]
    s_waitcnt lgkmcnt(7)
    v_mfma_f32_32x32x16_bf16 v[48:63], v[120:123], v[104:107], v[48:63]
    v_pk_fma_f32 v[224:225], v[188:189], v[160:161], v[224:225] op_sel:[1,1,0] op_sel_hi:[0,1,1] neg_lo:[1,0,0]
    v_pk_fma_f32 v[226:227], v[188:189], v[176:177], v[226:227] op_sel:[1,1,0] op_sel_hi:[0,1,1] neg_lo:[1,0,0]
    v_mfma_f32_32x32x16_bf16 v[64:79], v[136:139], v[104:107], v[64:79]
    v_pk_fma_f32 v[228:229], v[190:191], v[160:161], v[228:229] op_sel:[1,1,0] op_sel_hi:[0,1,1] neg_lo:[1,0,0]
    v_pk_fma_f32 v[230:231], v[190:191], v[176:177], v[230:231] op_sel:[1,1,0] op_sel_hi:[0,1,1] neg_lo:[1,0,0]
    v_mfma_f32_32x32x16_bf16 v[80:95], v[104:107], v[152:155], v[80:95]
    v_cvt_pk_bf16_f32 v215, v224, v225
    v_cvt_pk_bf16_f32 v216, v226, v227
    s_waitcnt lgkmcnt(0)
    s_barrier
    ds_read_b128 v[96:99], v32 offset:0
    ds_read_b64_tr_b16 v[112:113], v40 offset:0
    ds_read_b64_tr_b16 v[114:115], v40 offset:512
    v_mfma_f32_32x32x16_bf16 v[48:63], v[124:127], v[108:111], v[48:63]
    ds_read_b64_tr_b16 v[128:129], v41 offset:0
    ds_read_b64_tr_b16 v[130:131], v41 offset:512
    ds_read_b64_tr_b16 v[144:145], v42 offset:0
    v_mfma_f32_32x32x16_bf16 v[64:79], v[140:143], v[108:111], v[64:79]
    ds_read_b64_tr_b16 v[146:147], v42 offset:512
    ds_read_b128 v[100:103], v33 offset:0
    ds_read_b64_tr_b16 v[116:117], v40 offset:2048
    v_mfma_f32_32x32x16_bf16 v[80:95], v[108:111], v[156:159], v[80:95]
    ds_read_b64_tr_b16 v[118:119], v40 offset:2560
    ds_read_b64_tr_b16 v[132:133], v41 offset:2048
    ds_read_b64_tr_b16 v[134:135], v41 offset:2560
    ds_read_b64_tr_b16 v[148:149], v42 offset:2048
    ds_read_b64_tr_b16 v[150:151], v42 offset:2560
    v_cvt_pk_bf16_f32 v217, v228, v229
    v_cvt_pk_bf16_f32 v218, v230, v231
    s_waitcnt lgkmcnt(7)
    v_mfma_f32_32x32x16_bf16 v[48:63], v[112:115], v[96:99], v[48:63]
    ds_read_b128 v[104:107], v34 offset:0
    ds_read_b64_tr_b16 v[120:121], v40 offset:4096
    ds_read_b64_tr_b16 v[122:123], v40 offset:4608
    v_mfma_f32_32x32x16_bf16 v[64:79], v[128:131], v[96:99], v[64:79]
    ds_read_b64_tr_b16 v[136:137], v41 offset:4096
    ds_read_b64_tr_b16 v[138:139], v41 offset:4608
    v_mfma_f32_32x32x16_bf16 v[80:95], v[96:99], v[144:147], v[80:95]
    ds_read_b64_tr_b16 v[152:153], v42 offset:4096
    ds_read_b64_tr_b16 v[154:155], v42 offset:4608
    s_waitcnt lgkmcnt(7)
    v_mfma_f32_32x32x16_bf16 v[48:63], v[116:119], v[100:103], v[48:63]
    ds_read_b128 v[108:111], v35 offset:0
    ds_read_b64_tr_b16 v[124:125], v40 offset:6144
    ds_read_b64_tr_b16 v[126:127], v40 offset:6656
    v_mfma_f32_32x32x16_bf16 v[64:79], v[132:135], v[100:103], v[64:79]
    ds_read_b64_tr_b16 v[140:141], v41 offset:6144
    ds_read_b64_tr_b16 v[142:143], v41 offset:6656
    v_mfma_f32_32x32x16_bf16 v[80:95], v[100:103], v[148:151], v[80:95]
    ds_read_b64_tr_b16 v[156:157], v42 offset:6144
    ds_read_b64_tr_b16 v[158:159], v42 offset:6656
    s_waitcnt lgkmcnt(7)
    v_mfma_f32_32x32x16_bf16 v[48:63], v[120:123], v[104:107], v[48:63]
    v_mfma_f32_32x32x16_bf16 v[64:79], v[136:139], v[104:107], v[64:79]
    v_mfma_f32_32x32x16_bf16 v[80:95], v[104:107], v[152:155], v[80:95]
    s_waitcnt lgkmcnt(0)
    s_barrier
    ds_read_b128 v[96:99], v32 offset:32768
    ds_read_b64_tr_b16 v[112:113], v40 offset:32768
    ds_read_b64_tr_b16 v[114:115], v40 offset:33280
    v_mfma_f32_32x32x16_bf16 v[48:63], v[124:127], v[108:111], v[48:63]
    ds_read_b64_tr_b16 v[128:129], v41 offset:32768
    ds_read_b64_tr_b16 v[130:131], v41 offset:33280
    ds_read_b64_tr_b16 v[144:145], v42 offset:32768
    v_mfma_f32_32x32x16_bf16 v[64:79], v[140:143], v[108:111], v[64:79]
    ds_read_b64_tr_b16 v[146:147], v42 offset:33280
    ds_read_b128 v[100:103], v33 offset:32768
    ds_read_b64_tr_b16 v[116:117], v40 offset:34816
    v_mfma_f32_32x32x16_bf16 v[80:95], v[108:111], v[156:159], v[80:95]
    ds_read_b64_tr_b16 v[118:119], v40 offset:35328
    ds_read_b64_tr_b16 v[132:133], v41 offset:34816
    ds_read_b64_tr_b16 v[134:135], v41 offset:35328
    ds_read_b64_tr_b16 v[148:149], v42 offset:34816
    ds_read_b64_tr_b16 v[150:151], v42 offset:35328
    s_waitcnt lgkmcnt(7)
    v_mfma_f32_32x32x16_bf16 v[48:63], v[112:115], v[96:99], v[48:63]
    ds_read_b128 v[104:107], v34 offset:32768
    ds_read_b64_tr_b16 v[120:121], v40 offset:36864
    ds_read_b64_tr_b16 v[122:123], v40 offset:37376
    v_mfma_f32_32x32x16_bf16 v[64:79], v[128:131], v[96:99], v[64:79]
    ds_read_b64_tr_b16 v[136:137], v41 offset:36864
    ds_read_b64_tr_b16 v[138:139], v41 offset:37376
    v_mfma_f32_32x32x16_bf16 v[80:95], v[96:99], v[144:147], v[80:95]
    ds_read_b64_tr_b16 v[152:153], v42 offset:36864
    ds_read_b64_tr_b16 v[154:155], v42 offset:37376
    s_waitcnt lgkmcnt(7)
    v_mfma_f32_32x32x16_bf16 v[48:63], v[116:119], v[100:103], v[48:63]
    ds_read_b128 v[108:111], v35 offset:32768
    ds_read_b64_tr_b16 v[124:125], v40 offset:38912
    ds_read_b64_tr_b16 v[126:127], v40 offset:39424
    v_mfma_f32_32x32x16_bf16 v[64:79], v[132:135], v[100:103], v[64:79]
    ds_read_b64_tr_b16 v[140:141], v41 offset:38912
    ds_read_b64_tr_b16 v[142:143], v41 offset:39424
    v_mfma_f32_32x32x16_bf16 v[80:95], v[100:103], v[148:151], v[80:95]
    ds_read_b64_tr_b16 v[156:157], v42 offset:38912
    ds_read_b64_tr_b16 v[158:159], v42 offset:39424
    s_waitcnt lgkmcnt(7)
    v_mfma_f32_32x32x16_bf16 v[48:63], v[120:123], v[104:107], v[48:63]
    ds_write_b32 v219, v192 offset:0
    ds_write_b32 v219, v193 offset:528
    ds_write_b32 v219, v194 offset:1056
    v_mfma_f32_32x32x16_bf16 v[64:79], v[136:139], v[104:107], v[64:79]
    ds_write_b32 v219, v195 offset:1584
    ds_write_b32 v219, v196 offset:2112
    ds_write_b32 v219, v197 offset:2640
    v_mfma_f32_32x32x16_bf16 v[80:95], v[104:107], v[152:155], v[80:95]
    ds_write_b32 v219, v198 offset:3168
    ds_write_b32 v219, v199 offset:3696
    s_waitcnt lgkmcnt(8)
    v_mfma_f32_32x32x16_bf16 v[48:63], v[124:127], v[108:111], v[48:63]
    ds_write_b32 v219, v200 offset:4224
    ds_write_b32 v219, v201 offset:4752
    ds_write_b32 v219, v202 offset:5280
    ds_write_b32 v219, v203 offset:5808
    ds_write_b32 v219, v204 offset:6336
    ds_write_b32 v219, v205 offset:6864
    ds_write_b32 v219, v206 offset:7392
    v_mfma_f32_32x32x16_bf16 v[64:79], v[140:143], v[108:111], v[64:79]
    ds_write_b32 v219, v207 offset:7920
    ds_write_b32 v219, v208 offset:8448
    ds_write_b32 v219, v209 offset:8976
    ds_write_b32 v219, v210 offset:9504
    ds_write_b32 v219, v211 offset:10032
    ds_write_b32 v219, v212 offset:10560
    v_mfma_f32_32x32x16_bf16 v[80:95], v[108:111], v[156:159], v[80:95]
    ds_write_b32 v219, v213 offset:11088
    ds_write_b32 v219, v214 offset:11616
    ds_write_b32 v219, v215 offset:12144
    ds_write_b32 v219, v216 offset:12672
    ds_write_b32 v219, v217 offset:13200
    ds_write_b32 v219, v218 offset:13728
    s_add_u32 s74, s8, 0x300000
    s_add_u32 s75, s8, 0x310000
    s_add_u32 s76, s8, 0x500000
    s_add_u32 s77, s8, 0x110000
    s_add_u32 s73, s8, 0x100000
    s_waitcnt lgkmcnt(0)
    s_barrier
    v_cvt_pk_bf16_f32 v96, v56, v57
    v_cvt_pk_bf16_f32 v97, v58, v59
    v_cvt_pk_bf16_f32 v98, v60, v61
    v_cvt_pk_bf16_f32 v99, v62, v63
    buffer_store_dwordx4 v[96:99], v222, s[48:51], s74 offen sc1
    v_cvt_pk_bf16_f32 v100, v72, v73
    v_cvt_pk_bf16_f32 v101, v74, v75
    v_cvt_pk_bf16_f32 v102, v76, v77
    v_cvt_pk_bf16_f32 v103, v78, v79
    buffer_store_dwordx4 v[100:103], v222, s[48:51], s75 offen sc1
    v_cvt_pk_bf16_f32 v104, v80, v81
    v_cvt_pk_bf16_f32 v105, v82, v83
    v_cvt_pk_bf16_f32 v106, v84, v85
    v_cvt_pk_bf16_f32 v107, v86, v87
    buffer_store_dwordx4 v[104:107], v223, s[48:51], s76 offen sc1
    v_cvt_pk_bf16_f32 v108, v88, v89
    v_cvt_pk_bf16_f32 v109, v90, v91
    v_cvt_pk_bf16_f32 v110, v92, v93
    v_cvt_pk_bf16_f32 v111, v94, v95
    buffer_store_dwordx4 v[108:111], v223, s[48:51], s76 offen offset:512 sc1
    v_mul_f32 v48, 0x3eb8aa3b, v48
    v_mul_f32 v49, 0x3eb8aa3b, v49
    v_mul_f32 v50, 0x3eb8aa3b, v50
    v_mul_f32 v51, 0x3eb8aa3b, v51
    v_mul_f32 v52, 0x3eb8aa3b, v52
    v_mul_f32 v53, 0x3eb8aa3b, v53
    v_mul_f32 v54, 0x3eb8aa3b, v54
    v_mul_f32 v55, 0x3eb8aa3b, v55
    v_cvt_pk_bf16_f32 v112, v48, v49
    v_cvt_pk_bf16_f32 v113, v50, v51
    v_cvt_pk_bf16_f32 v114, v52, v53
    v_cvt_pk_bf16_f32 v115, v54, v55
    buffer_store_dwordx4 v[112:115], v222, s[48:51], s73 offen sc1
    v_mul_f32 v64, 0x3eb8aa3b, v64
    v_mul_f32 v65, 0x3eb8aa3b, v65
    v_mul_f32 v66, 0x3eb8aa3b, v66
    v_mul_f32 v67, 0x3eb8aa3b, v67
    v_mul_f32 v68, 0x3eb8aa3b, v68
    v_mul_f32 v69, 0x3eb8aa3b, v69
    v_mul_f32 v70, 0x3eb8aa3b, v70
    v_mul_f32 v71, 0x3eb8aa3b, v71
    v_cvt_pk_bf16_f32 v116, v64, v65
    v_cvt_pk_bf16_f32 v117, v66, v67
    v_cvt_pk_bf16_f32 v118, v68, v69
    v_cvt_pk_bf16_f32 v119, v70, v71
    buffer_store_dwordx4 v[116:119], v222, s[48:51], s77 offen sc1
    s_bfe_u32 s39, s66, 0x10001
    v_lshrrev_b32 v14, 5, v1
    v_and_b32 v15, 7, v1
    v_bfe_u32 v16, v1, 3, 2
    v_bfe_u32 v17, v1, 2, 2
    v_bfe_u32 v18, v1, 4, 1
    v_and_b32 v19, 15, v1
    v_lshrrev_b32 v20, 3, v1
    s_cmp_eq_u32 s39, 1
    s_mov_b32 s73, 146400
    s_cselect_b32 s73, 150560, s73
    s_mov_b32 s74, 154624
    s_cselect_b32 s74, 159232, s74
    s_mov_b32 s75, 70352
    s_cselect_b32 s75, 108368, s75
    v_and_b32 v22, 3, v1
    v_lshl_add_u32 v22, v18, 2, v22
    v_lshl_add_u32 v23, v14, 3, v17
    v_sub_u32 v22, v22, v23
    v_lshlrev_b32 v22, 3, v22
    v_add_u32 v224, s73, v22
    v_mul_u32_u24 v22, 0x480, v16
    v_add_u32 v24, v15, v14
    v_lshl_add_u32 v22, v24, 4, v22
    v_add_u32 v225, s74, v22
    v_mul_u32_u24 v22, 0x2520, v16
    v_mul_u32_u24 v24, 0x90, v15
    v_lshl_add_u32 v24, v14, 4, v24
    v_add3_u32 v226, v22, v24, s75
    s_lshl_b32 s9, s7, 5
    s_add_u32 s9, s9, s6
    s_lshl_b32 s9, s9, 7
    s_add_u32 s9, s9, 0x1000
    s_lshl_b32 s73, s64, 12
    s_add_u32 s10, s73, 0x1000
    s_add_u32 s17, s73, 0xa000
    s_lshl_b32 s18, s70, 16
    s_mov_b32 s97, 0
L_gemm_done:
    s_waitcnt lgkmcnt(0)
    s_barrier
    s_cmp_ge_u32 s66, 4
    s_cbranch_scc1 L_conv_hi
    s_bitcmp1_b32 s66, 0
    s_cbranch_scc1 L_conv_2a
    ds_read_b64_tr_b16 v[160:161], v224 offset:32
    ds_read_b64_tr_b16 v[162:163], v224 offset:0
    ds_read_b128 v[192:195], v225 offset:240
    ds_read_b128 v[176:179], v225 offset:112
    ds_read_b64_tr_b16 v[164:165], v224 offset:160
    ds_read_b64_tr_b16 v[166:167], v224 offset:128
    ds_read_b128 v[196:199], v225 offset:208
    ds_read_b128 v[180:183], v225 offset:80
    ds_read_b64_tr_b16 v[168:169], v224 offset:288
    ds_read_b64_tr_b16 v[170:171], v224 offset:256
    ds_read_b128 v[200:203], v225 offset:176
    ds_read_b128 v[184:187], v225 offset:48
    ds_read_b64_tr_b16 v[172:173], v224 offset:416
    ds_read_b64_tr_b16 v[174:175], v224 offset:384
    ds_read_b128 v[204:207], v225 offset:144
    ds_read_b128 v[188:191], v225 offset:16
    v_mov_b32 v20, 0x23b50
    v_mov_b32 v21, 1
    s_waitcnt vmcnt(0)
    s_mov_b64 exec, 1
    ds_add_rtn_u32 v21, v20, v21
    s_mov_b64 exec, -1
    s_waitcnt lgkmcnt(0)
    v_readfirstlane_b32 s73, v21
    s_cmp_eq_u32 s73, 3
    s_cbranch_scc0 L_sig_a
    v_mov_b32 v18, 0
    v_mov_b32 v19, s67
    s_mov_b64 exec, 1
    buffer_store_dword v19, v18, s[48:51], s9 offen sc1
    s_mov_b64 exec, -1
L_sig_a:
    s_waitcnt lgkmcnt(0)
    v_mfma_f32_32x32x16_bf16 v[144:159], v[160:163], v[192:195], 0
    v_and_b32 v31, 31, v1
    v_cmp_eq_u32 vcc, 16, v31
    v_mov_b32 v31, 0x3f803f80
    v_mfma_f32_32x32x16_bf16 v[128:143], v[160:163], v[176:179], 0
    v_mov_b32 v255, 0xdddddddd
    s_mov_b32 s4, 0xffff
    s_mov_b32 s5, 0xffff
    ds_read_b64_tr_b16 v[160:161], v224 offset:544
    ds_read_b64_tr_b16 v[162:163], v224 offset:512
    s_waitcnt lgkmcnt(2)
    v_mfma_f32_32x32x16_bf16 v[144:159], v[164:167], v[196:199], v[144:159]
    v_cndmask_b32 v208, 0, v31, vcc
    v_cndmask_b32 v209, 0, v31, vcc
    v_cndmask_b32 v210, 0, v31, vcc
    v_mfma_f32_32x32x16_bf16 v[128:143], v[164:167], v[180:183], v[128:143]
    v_cndmask_b32 v211, 0, v31, vcc
    v_cndmask_b32 v212, 0, v31, vcc
    v_cndmask_b32 v213, 0, v31, vcc
    ds_read_b64_tr_b16 v[164:165], v224 offset:672
    ds_read_b64_tr_b16 v[166:167], v224 offset:640
    s_waitcnt lgkmcnt(4)
    v_mfma_f32_32x32x16_bf16 v[144:159], v[168:171], v[200:203], v[144:159]
    v_cndmask_b32 v214, 0, v31, vcc
    v_cndmask_b32 v215, 0, v31, vcc
    v_cndmask_b32 v216, 0, v31, vcc
    v_mfma_f32_32x32x16_bf16 v[128:143], v[168:171], v[184:187], v[128:143]
    v_cndmask_b32 v217, 0, v31, vcc
    v_cndmask_b32 v218, 0, v31, vcc
    v_cndmask_b32 v219, 0, v31, vcc
    ds_read_b64_tr_b16 v[168:169], v224 offset:800
    ds_read_b64_tr_b16 v[170:171], v224 offset:768
    s_waitcnt lgkmcnt(6)
    v_mfma_f32_32x32x16_bf16 v[144:159], v[172:175], v[204:207], v[144:159]
    v_cndmask_b32 v220, 0, v31, vcc
    v_cndmask_b32 v221, 0, v31, vcc
    v_cndmask_b32 v222, 0, v31, vcc
    v_mfma_f32_32x32x16_bf16 v[128:143], v[172:175], v[188:191], v[128:143]
    v_cndmask_b32 v223, 0, v31, vcc
    v_mov_b32 v72, 0
    v_mov_b32 v73, 0
    ds_read_b64_tr_b16 v[172:173], v224 offset:928
    ds_read_b64_tr_b16 v[174:175], v224 offset:896
    s_waitcnt lgkmcnt(6)
    v_mfma_f32_32x32x16_bf16 v[144:159], v[160:163], v[176:179], v[144:159]
    v_mov_b32 v74, 0
    v_mov_b32 v75, 0
    v_mov_b32 v76, 0
    s_waitcnt lgkmcnt(4)
    v_mfma_f32_32x32x16_bf16 v[144:159], v[164:167], v[180:183], v[144:159]
    v_mov_b32 v77, 0
    v_mov_b32 v78, 0
    v_mov_b32 v79, 0
    s_waitcnt lgkmcnt(2)
    v_mfma_f32_32x32x16_bf16 v[144:159], v[168:171], v[184:187], v[144:159]
    v_mov_b32 v80, 0
    v_mov_b32 v81, 0
    v_mov_b32 v82, 0
    s_waitcnt lgkmcnt(0)
    v_mfma_f32_32x32x16_bf16 v[144:159], v[172:175], v[188:191], v[144:159]
    v_mov_b32 v83, 0
    v_mov_b32 v84, 0
    v_mov_b32 v85, 0
    v_mov_b32 v86, 0
    v_mov_b32 v87, 0
    v_mov_b32 v88, 0
    v_mov_b32 v89, 0
    v_mov_b32 v90, 0
    v_mov_b32 v91, 0
    v_mov_b32 v92, 0
    v_mov_b32 v93, 0
    v_mov_b32 v94, 0
    v_mov_b32 v95, 0
    v_mov_b32 v96, 0
    v_mov_b32 v97, 0
    v_mov_b32 v98, 0
    v_mov_b32 v99, 0
    v_mov_b32 v100, 0
    v_mov_b32 v101, 0
    v_mov_b32 v102, 0
    v_mov_b32 v103, 0
    ds_write_b128 v226, v[128:131] offset:0
    ds_write_b128 v226, v[132:135] offset:32
    ds_write_b128 v226, v[136:139] offset:64
    ds_write_b128 v226, v[140:143] offset:96
    s_nop 7
    ds_write_b128 v226, v[144:147] offset:1152
    ds_write_b128 v226, v[148:151] offset:1184
    ds_write_b128 v226, v[152:155] offset:1216
    ds_write_b128 v226, v[156:159] offset:1248
    s_branch L_conv_done
L_conv_2a:
    ds_read_b64_tr_b16 v[160:161], v224 offset:32
    ds_read_b64_tr_b16 v[162:163], v224 offset:0
    ds_read_b128 v[192:195], v225 offset:752
    ds_read_b128 v[176:179], v225 offset:624
    ds_read_b64_tr_b16 v[164:165], v224 offset:160
    ds_read_b64_tr_b16 v[166:167], v224 offset:128
    ds_read_b128 v[196:199], v225 offset:720
    ds_read_b128 v[180:183], v225 offset:592
    ds_read_b64_tr_b16 v[168:169], v224 offset:288
    ds_read_b64_tr_b16 v[170:171], v224 offset:256
    ds_read_b128 v[200:203], v225 offset:688
    ds_read_b128 v[184:187], v225 offset:560
    ds_read_b64_tr_b16 v[172:173], v224 offset:416
    ds_read_b64_tr_b16 v[174:175], v224 offset:384
    ds_read_b128 v[204:207], v225 offset:656
    ds_read_b128 v[188:191], v225 offset:528
    v_mov_b32 v20, 0x23b50
    v_mov_b32 v21, 1
    s_waitcnt vmcnt(0)
    s_mov_b64 exec, 1
    ds_add_rtn_u32 v21, v20, v21
    s_mov_b64 exec, -1
    s_waitcnt lgkmcnt(0)
    v_readfirstlane_b32 s73, v21
    s_cmp_eq_u32 s73, 3
    s_cbranch_scc0 L_sig_b
    v_mov_b32 v18, 0
    v_mov_b32 v19, s67
    s_mov_b64 exec, 1
    buffer_store_dword v19, v18, s[48:51], s9 offen sc1
    s_mov_b64 exec, -1
L_sig_b:
    s_waitcnt lgkmcnt(0)
    v_mfma_f32_32x32x16_bf16 v[144:159], v[160:163], v[192:195], 0
    v_and_b32 v31, 31, v1
    v_cmp_eq_u32 vcc, 16, v31
    v_mov_b32 v31, 0x3f803f80
    ds_read_b128 v[192:195], v225 offset:496
    v_mfma_f32_32x32x16_bf16 v[128:143], v[160:163], v[176:179], 0
    v_mov_b32 v255, 0xdddddddd
    s_mov_b32 s4, 0xffff
    s_mov_b32 s5, 0xffff
    ds_read_b64_tr_b16 v[160:161], v224 offset:544
    ds_read_b64_tr_b16 v[162:163], v224 offset:512
    s_waitcnt lgkmcnt(3)
    v_mfma_f32_32x32x16_bf16 v[144:159], v[164:167], v[196:199], v[144:159]
    v_cndmask_b32 v208, 0, v31, vcc
    v_cndmask_b32 v209, 0, v31, vcc
    v_cndmask_b32 v210, 0, v31, vcc
    ds_read_b128 v[196:199], v225 offset:464
    v_mfma_f32_32x32x16_bf16 v[128:143], v[164:167], v[180:183], v[128:143]
    v_cndmask_b32 v211, 0, v31, vcc
    v_cndmask_b32 v212, 0, v31, vcc
    v_cndmask_b32 v213, 0, v31, vcc
    ds_read_b64_tr_b16 v[164:165], v224 offset:672
    ds_read_b64_tr_b16 v[166:167], v224 offset:640
    s_waitcnt lgkmcnt(6)
    v_mfma_f32_32x32x16_bf16 v[144:159], v[168:171], v[200:203], v[144:159]
    v_cndmask_b32 v214, 0, v31, vcc
    v_cndmask_b32 v215, 0, v31, vcc
    v_cndmask_b32 v216, 0, v31, vcc
    ds_read_b128 v[200:203], v225 offset:432
    v_mfma_f32_32x32x16_bf16 v[128:143], v[168:171], v[184:187], v[128:143]
    v_cndmask_b32 v217, 0, v31, vcc
    v_cndmask_b32 v218, 0, v31, vcc
    v_cndmask_b32 v219, 0, v31, vcc
    ds_read_b64_tr_b16 v[168:169], v224 offset:800
    ds_read_b64_tr_b16 v[170:171], v224 offset:768
    s_waitcnt lgkmcnt(9)
    v_mfma_f32_32x32x16_bf16 v[144:159], v[172:175], v[204:207], v[144:159]
    v_cndmask_b32 v220, 0, v31, vcc
    v_cndmask_b32 v221, 0, v31, vcc
    v_cndmask_b32 v222, 0, v31, vcc
    ds_read_b128 v[204:207], v225 offset:400
    v_mfma_f32_32x32x16_bf16 v[128:143], v[172:175], v[188:191], v[128:143]
    v_cndmask_b32 v223, 0, v31, vcc
    v_mov_b32 v72, 0
    v_mov_b32 v73, 0
    ds_read_b64_tr_b16 v[172:173], v224 offset:928
    ds_read_b64_tr_b16 v[174:175], v224 offset:896
    s_waitcnt lgkmcnt(9)
    v_mfma_f32_32x32x16_bf16 v[144:159], v[160:163], v[176:179], v[144:159]
    v_mov_b32 v74, 0
    v_mov_b32 v75, 0
    v_mov_b32 v76, 0
    ds_read_b128 v[176:179], v225 offset:368
    v_mfma_f32_32x32x16_bf16 v[128:143], v[160:163], v[192:195], v[128:143]
    v_mov_b32 v77, 0
    v_mov_b32 v78, 0
    v_mov_b32 v79, 0
    ds_read_b64_tr_b16 v[160:161], v224 offset:1056
    ds_read_b64_tr_b16 v[162:163], v224 offset:1024
    s_waitcnt lgkmcnt(9)
    v_mfma_f32_32x32x16_bf16 v[144:159], v[164:167], v[180:183], v[144:159]
    v_mov_b32 v80, 0
    v_mov_b32 v81, 0
    v_mov_b32 v82, 0
    ds_read_b128 v[180:183], v225 offset:336
    v_mfma_f32_32x32x16_bf16 v[128:143], v[164:167], v[196:199], v[128:143]
    v_mov_b32 v83, 0
    v_mov_b32 v84, 0
    v_mov_b32 v85, 0
    ds_read_b64_tr_b16 v[164:165], v224 offset:1184
    ds_read_b64_tr_b16 v[166:167], v224 offset:1152
    s_waitcnt lgkmcnt(9)
    v_mfma_f32_32x32x16_bf16 v[144:159], v[168:171], v[184:187], v[144:159]
    v_mov_b32 v86, 0
    v_mov_b32 v87, 0
    v_mov_b32 v88, 0
    ds_read_b128 v[184:187], v225 offset:304
    v_mfma_f32_32x32x16_bf16 v[128:143], v[168:171], v[200:203], v[128:143]
    v_mov_b32 v89, 0
    v_mov_b32 v90, 0
    v_mov_b32 v91, 0
    ds_read_b64_tr_b16 v[168:169], v224 offset:1312
    ds_read_b64_tr_b16 v[170:171], v224 offset:1280
    s_waitcnt lgkmcnt(9)
    v_mfma_f32_32x32x16_bf16 v[144:159], v[172:175], v[188:191], v[144:159]
    v_mov_b32 v92, 0
    v_mov_b32 v93, 0
    v_mov_b32 v94, 0
    ds_read_b128 v[188:191], v225 offset:272
    v_mfma_f32_32x32x16_bf16 v[128:143], v[172:175], v[204:207], v[128:143]
    v_mov_b32 v95, 0
    v_mov_b32 v96, 0
    v_mov_b32 v97, 0
    ds_read_b64_tr_b16 v[172:173], v224 offset:1440
    ds_read_b64_tr_b16 v[174:175], v224 offset:1408
    s_waitcnt lgkmcnt(9)
    v_mfma_f32_32x32x16_bf16 v[144:159], v[160:163], v[192:195], v[144:159]
    v_mov_b32 v98, 0
    v_mov_b32 v99, 0
    v_mov_b32 v100, 0
    v_mfma_f32_32x32x16_bf16 v[128:143], v[160:163], v[176:179], v[128:143]
    v_mov_b32 v101, 0
    v_mov_b32 v102, 0
    v_mov_b32 v103, 0
    s_waitcnt lgkmcnt(6)
    v_mfma_f32_32x32x16_bf16 v[144:159], v[164:167], v[196:199], v[144:159]
    v_mfma_f32_32x32x16_bf16 v[128:143], v[164:167], v[180:183], v[128:143]
    s_waitcnt lgkmcnt(3)
    v_mfma_f32_32x32x16_bf16 v[144:159], v[168:171], v[200:203], v[144:159]
    v_mfma_f32_32x32x16_bf16 v[128:143], v[168:171], v[184:187], v[128:143]
    s_waitcnt lgkmcnt(0)
    v_mfma_f32_32x32x16_bf16 v[144:159], v[172:175], v[204:207], v[144:159]
    v_mfma_f32_32x32x16_bf16 v[128:143], v[172:175], v[188:191], v[128:143]
    s_nop 11
    ds_write_b128 v226, v[128:131] offset:4608
    ds_write_b128 v226, v[132:135] offset:4640
    ds_write_b128 v226, v[136:139] offset:4672
    ds_write_b128 v226, v[140:143] offset:4704
    s_nop 7
    ds_write_b128 v226, v[144:147] offset:5760
    ds_write_b128 v226, v[148:151] offset:5792
    ds_write_b128 v226, v[152:155] offset:5824
    ds_write_b128 v226, v[156:159] offset:5856
    s_branch L_conv_done
L_conv_hi:
    s_bitcmp1_b32 s66, 0
    s_cbranch_scc1 L_conv_2b
    ds_read_b64_tr_b16 v[160:161], v224 offset:32
    ds_read_b64_tr_b16 v[162:163], v224 offset:0
    ds_read_b128 v[192:195], v225 offset:496
    ds_read_b128 v[176:179], v225 offset:368
    ds_read_b64_tr_b16 v[164:165], v224 offset:160
    ds_read_b64_tr_b16 v[166:167], v224 offset:128
    ds_read_b128 v[196:199], v225 offset:464
    ds_read_b128 v[180:183], v225 offset:336
    ds_read_b64_tr_b16 v[168:169], v224 offset:288
    ds_read_b64_tr_b16 v[170:171], v224 offset:256
    ds_read_b128 v[200:203], v225 offset:432
    ds_read_b128 v[184:187], v225 offset:304
    ds_read_b64_tr_b16 v[172:173], v224 offset:416
    ds_read_b64_tr_b16 v[174:175], v224 offset:384
    ds_read_b128 v[204:207], v225 offset:400
    ds_read_b128 v[188:191], v225 offset:272
    s_waitcnt lgkmcnt(12)
    v_mfma_f32_32x32x16_bf16 v[144:159], v[160:163], v[192:195], 0
    v_and_b32 v31, 31, v1
    v_cmp_eq_u32 vcc, 16, v31
    v_mov_b32 v31, 0x3f803f80
    ds_read_b128 v[192:195], v225 offset:240
    v_mfma_f32_32x32x16_bf16 v[128:143], v[160:163], v[176:179], 0
    v_mov_b32 v255, 0xdddddddd
    s_mov_b32 s4, 0xffff
    s_mov_b32 s5, 0xffff
    ds_read_b64_tr_b16 v[160:161], v224 offset:544
    ds_read_b64_tr_b16 v[162:163], v224 offset:512
    s_waitcnt lgkmcnt(11)
    v_mfma_f32_32x32x16_bf16 v[144:159], v[164:167], v[196:199], v[144:159]
    v_cndmask_b32 v208, 0, v31, vcc
    v_cndmask_b32 v209, 0, v31, vcc
    v_cndmask_b32 v210, 0, v31, vcc
    ds_read_b128 v[196:199], v225 offset:208
    v_mfma_f32_32x32x16_bf16 v[128:143], v[164:167], v[180:183], v[128:143]
    v_cndmask_b32 v211, 0, v31, vcc
    v_cndmask_b32 v212, 0, v31, vcc
    v_cndmask_b32 v213, 0, v31, vcc
    ds_read_b64_tr_b16 v[164:165], v224 offset:672
    ds_read_b64_tr_b16 v[166:167], v224 offset:640
    s_waitcnt lgkmcnt(10)
    v_mfma_f32_32x32x16_bf16 v[144:159], v[168:171], v[200:203], v[144:159]
    v_cndmask_b32 v214, 0, v31, vcc
    v_cndmask_b32 v215, 0, v31, vcc
    v_cndmask_b32 v216, 0, v31, vcc
    ds_read_b128 v[200:203], v225 offset:176
    v_mfma_f32_32x32x16_bf16 v[128:143], v[168:171], v[184:187], v[128:143]
    v_cndmask_b32 v217, 0, v31, vcc
    v_cndmask_b32 v218, 0, v31, vcc
    v_cndmask_b32 v219, 0, v31, vcc
    ds_read_b64_tr_b16 v[168:169], v224 offset:800
    ds_read_b64_tr_b16 v[170:171], v224 offset:768
    s_waitcnt lgkmcnt(9)
    v_mfma_f32_32x32x16_bf16 v[144:159], v[172:175], v[204:207], v[144:159]
    v_cndmask_b32 v220, 0, v31, vcc
    v_cndmask_b32 v221, 0, v31, vcc
    v_cndmask_b32 v222, 0, v31, vcc
    ds_read_b128 v[204:207], v225 offset:144
    v_mfma_f32_32x32x16_bf16 v[128:143], v[172:175], v[188:191], v[128:143]
    v_cndmask_b32 v223, 0, v31, vcc
    v_mov_b32 v72, 0
    v_mov_b32 v73, 0
    ds_read_b64_tr_b16 v[172:173], v224 offset:928
    ds_read_b64_tr_b16 v[174:175], v224 offset:896
    s_waitcnt lgkmcnt(9)
    v_mfma_f32_32x32x16_bf16 v[144:159], v[160:163], v[176:179], v[144:159]
    v_mov_b32 v74, 0
    v_mov_b32 v75, 0
    v_mov_b32 v76, 0
    ds_read_b128 v[176:179], v225 offset:112
    v_mfma_f32_32x32x16_bf16 v[128:143], v[160:163], v[192:195], v[128:143]
    v_mov_b32 v77, 0
    v_mov_b32 v78, 0
    v_mov_b32 v79, 0
    ds_read_b64_tr_b16 v[160:161], v224 offset:1056
    ds_read_b64_tr_b16 v[162:163], v224 offset:1024
    s_waitcnt lgkmcnt(9)
    v_mfma_f32_32x32x16_bf16 v[144:159], v[164:167], v[180:183], v[144:159]
    v_mov_b32 v80, 0
    v_mov_b32 v81, 0
    v_mov_b32 v82, 0
    ds_read_b128 v[180:183], v225 offset:80
    v_mfma_f32_32x32x16_bf16 v[128:143], v[164:167], v[196:199], v[128:143]
    v_mov_b32 v83, 0
    v_mov_b32 v84, 0
    v_mov_b32 v85, 0
    ds_read_b64_tr_b16 v[164:165], v224 offset:1184
    ds_read_b64_tr_b16 v[166:167], v224 offset:1152
    s_waitcnt lgkmcnt(9)
    v_mfma_f32_32x32x16_bf16 v[144:159], v[168:171], v[184:187], v[144:159]
    v_mov_b32 v86, 0
    v_mov_b32 v87, 0
    v_mov_b32 v88, 0
    ds_read_b128 v[184:187], v225 offset:48
    v_mfma_f32_32x32x16_bf16 v[128:143], v[168:171], v[200:203], v[128:143]
    v_mov_b32 v89, 0
    v_mov_b32 v90, 0
    v_mov_b32 v91, 0
    ds_read_b64_tr_b16 v[168:169], v224 offset:1312
    ds_read_b64_tr_b16 v[170:171], v224 offset:1280
    s_waitcnt lgkmcnt(9)
    v_mfma_f32_32x32x16_bf16 v[144:159], v[172:175], v[188:191], v[144:159]
    v_mov_b32 v92, 0
    v_mov_b32 v93, 0
    v_mov_b32 v94, 0
    ds_read_b128 v[188:191], v225 offset:16
    v_mfma_f32_32x32x16_bf16 v[128:143], v[172:175], v[204:207], v[128:143]
    v_mov_b32 v95, 0
    v_mov_b32 v96, 0
    v_mov_b32 v97, 0
    ds_read_b64_tr_b16 v[172:173], v224 offset:1440
    ds_read_b64_tr_b16 v[174:175], v224 offset:1408
    s_waitcnt lgkmcnt(9)
    v_mfma_f32_32x32x16_bf16 v[144:159], v[160:163], v[192:195], v[144:159]
    v_mov_b32 v98, 0
    v_mov_b32 v99, 0
    v_mov_b32 v100, 0
    v_mfma_f32_32x32x16_bf16 v[128:143], v[160:163], v[176:179], v[128:143]
    v_mov_b32 v101, 0
    v_mov_b32 v102, 0
    v_mov_b32 v103, 0
    ds_read_b64_tr_b16 v[160:161], v224 offset:1568
    ds_read_b64_tr_b16 v[162:163], v224 offset:1536
    s_waitcnt lgkmcnt(8)
    v_mfma_f32_32x32x16_bf16 v[144:159], v[164:167], v[196:199], v[144:159]
    v_mfma_f32_32x32x16_bf16 v[128:143], v[164:167], v[180:183], v[128:143]
    ds_read_b64_tr_b16 v[164:165], v224 offset:1696
    ds_read_b64_tr_b16 v[166:167], v224 offset:1664
    s_waitcnt lgkmcnt(7)
    v_mfma_f32_32x32x16_bf16 v[144:159], v[168:171], v[200:203], v[144:159]
    v_mfma_f32_32x32x16_bf16 v[128:143], v[168:171], v[184:187], v[128:143]
    ds_read_b64_tr_b16 v[168:169], v224 offset:1824
    ds_read_b64_tr_b16 v[170:171], v224 offset:1792
    s_waitcnt lgkmcnt(6)
    v_mfma_f32_32x32x16_bf16 v[144:159], v[172:175], v[204:207], v[144:159]
    v_mfma_f32_32x32x16_bf16 v[128:143], v[172:175], v[188:191], v[128:143]
    ds_read_b64_tr_b16 v[172:173], v224 offset:1952
    ds_read_b64_tr_b16 v[174:175], v224 offset:1920
    s_waitcnt lgkmcnt(6)
    v_mfma_f32_32x32x16_bf16 v[144:159], v[160:163], v[176:179], v[144:159]
    s_waitcnt lgkmcnt(4)
    v_mfma_f32_32x32x16_bf16 v[144:159], v[164:167], v[180:183], v[144:159]
    s_waitcnt lgkmcnt(2)
    v_mfma_f32_32x32x16_bf16 v[144:159], v[168:171], v[184:187], v[144:159]
    s_waitcnt lgkmcnt(0)
    v_mfma_f32_32x32x16_bf16 v[144:159], v[172:175], v[188:191], v[144:159]
    s_nop 1
    ds_write_b128 v226, v[128:131] offset:2304
    ds_write_b128 v226, v[132:135] offset:2336
    ds_write_b128 v226, v[136:139] offset:2368
    ds_write_b128 v226, v[140:143] offset:2400
    s_nop 7
    ds_write_b128 v226, v[144:147] offset:3456
    ds_write_b128 v226, v[148:151] offset:3488
    ds_write_b128 v226, v[152:155] offset:3520
    ds_write_b128 v226, v[156:159] offset:3552
    s_branch L_conv_done
L_conv_2b:
    ds_read_b64_tr_b16 v[160:161], v224 offset:1568
    ds_read_b64_tr_b16 v[162:163], v224 offset:1536
    ds_read_b128 v[192:195], v225 offset:368
    ds_read_b128 v[176:179], v225 offset:240
    ds_read_b64_tr_b16 v[164:165], v224 offset:1696
    ds_read_b64_tr_b16 v[166:167], v224 offset:1664
    ds_read_b128 v[196:199], v225 offset:336
    ds_read_b128 v[180:183], v225 offset:208
    ds_read_b64_tr_b16 v[168:169], v224 offset:1824
    ds_read_b64_tr_b16 v[170:171], v224 offset:1792
    ds_read_b128 v[200:203], v225 offset:304
    ds_read_b128 v[184:187], v225 offset:176
    ds_read_b64_tr_b16 v[172:173], v224 offset:1952
    ds_read_b64_tr_b16 v[174:175], v224 offset:1920
    ds_read_b128 v[204:207], v225 offset:272
    ds_read_b128 v[188:191], v225 offset:144
    s_waitcnt lgkmcnt(12)
    v_mfma_f32_32x32x16_bf16 v[144:159], v[160:163], v[192:195], 0
    v_and_b32 v31, 31, v1
    v_cmp_eq_u32 vcc, 16, v31
    v_mov_b32 v31, 0x3f803f80
    ds_read_b128 v[192:195], v225 offset:112
    v_mfma_f32_32x32x16_bf16 v[128:143], v[160:163], v[176:179], 0
    v_mov_b32 v255, 0xdddddddd
    s_mov_b32 s4, 0xffff
    s_mov_b32 s5, 0xffff
    ds_read_b64_tr_b16 v[160:161], v224 offset:2080
    ds_read_b64_tr_b16 v[162:163], v224 offset:2048
    s_waitcnt lgkmcnt(11)
    v_mfma_f32_32x32x16_bf16 v[144:159], v[164:167], v[196:199], v[144:159]
    v_cndmask_b32 v208, 0, v31, vcc
    v_cndmask_b32 v209, 0, v31, vcc
    v_cndmask_b32 v210, 0, v31, vcc
    ds_read_b128 v[196:199], v225 offset:80
    v_mfma_f32_32x32x16_bf16 v[128:143], v[164:167], v[180:183], v[128:143]
    v_cndmask_b32 v211, 0, v31, vcc
    v_cndmask_b32 v212, 0, v31, vcc
    v_cndmask_b32 v213, 0, v31, vcc
    ds_read_b64_tr_b16 v[164:165], v224 offset:2208
    ds_read_b64_tr_b16 v[166:167], v224 offset:2176
    s_waitcnt lgkmcnt(10)
    v_mfma_f32_32x32x16_bf16 v[144:159], v[168:171], v[200:203], v[144:159]
    v_cndmask_b32 v214, 0, v31, vcc
    v_cndmask_b32 v215, 0, v31, vcc
    v_cndmask_b32 v216, 0, v31, vcc
    ds_read_b128 v[200:203], v225 offset:48
    v_mfma_f32_32x32x16_bf16 v[128:143], v[168:171], v[184:187], v[128:143]
    v_cndmask_b32 v217, 0, v31, vcc
    v_cndmask_b32 v218, 0, v31, vcc
    v_cndmask_b32 v219, 0, v31, vcc
    ds_read_b64_tr_b16 v[168:169], v224 offset:2336
    ds_read_b64_tr_b16 v[170:171], v224 offset:2304
    s_waitcnt lgkmcnt(9)
    v_mfma_f32_32x32x16_bf16 v[144:159], v[172:175], v[204:207], v[144:159]
    v_cndmask_b32 v220, 0, v31, vcc
    v_cndmask_b32 v221, 0, v31, vcc
    v_cndmask_b32 v222, 0, v31, vcc
    ds_read_b128 v[204:207], v225 offset:16
    v_mfma_f32_32x32x16_bf16 v[128:143], v[172:175], v[188:191], v[128:143]
    v_cndmask_b32 v223, 0, v31, vcc
    v_mov_b32 v72, 0
    v_mov_b32 v73, 0
    ds_read_b64_tr_b16 v[172:173], v224 offset:2464
    ds_read_b64_tr_b16 v[174:175], v224 offset:2432
    s_waitcnt lgkmcnt(9)
    v_mfma_f32_32x32x16_bf16 v[144:159], v[160:163], v[176:179], v[144:159]
    v_mov_b32 v74, 0
    v_mov_b32 v75, 0
    v_mov_b32 v76, 0
    v_mfma_f32_32x32x16_bf16 v[128:143], v[160:163], v[192:195], v[128:143]
    v_mov_b32 v77, 0
    v_mov_b32 v78, 0
    v_mov_b32 v79, 0
    ds_read_b64_tr_b16 v[160:161], v224 offset:2592
    ds_read_b64_tr_b16 v[162:163], v224 offset:2560
    s_waitcnt lgkmcnt(8)
    v_mfma_f32_32x32x16_bf16 v[144:159], v[164:167], v[180:183], v[144:159]
    v_mov_b32 v80, 0
    v_mov_b32 v81, 0
    v_mov_b32 v82, 0
    v_mfma_f32_32x32x16_bf16 v[128:143], v[164:167], v[196:199], v[128:143]
    v_mov_b32 v83, 0
    v_mov_b32 v84, 0
    v_mov_b32 v85, 0
    ds_read_b64_tr_b16 v[164:165], v224 offset:2720
    ds_read_b64_tr_b16 v[166:167], v224 offset:2688
    s_waitcnt lgkmcnt(7)
    v_mfma_f32_32x32x16_bf16 v[144:159], v[168:171], v[184:187], v[144:159]
    v_mov_b32 v86, 0
    v_mov_b32 v87, 0
    v_mov_b32 v88, 0
    v_mfma_f32_32x32x16_bf16 v[128:143], v[168:171], v[200:203], v[128:143]
    v_mov_b32 v89, 0
    v_mov_b32 v90, 0
    v_mov_b32 v91, 0
    ds_read_b64_tr_b16 v[168:169], v224 offset:2848
    ds_read_b64_tr_b16 v[170:171], v224 offset:2816
    s_waitcnt lgkmcnt(6)
    v_mfma_f32_32x32x16_bf16 v[144:159], v[172:175], v[188:191], v[144:159]
    v_mov_b32 v92, 0
    v_mov_b32 v93, 0
    v_mov_b32 v94, 0
    v_mfma_f32_32x32x16_bf16 v[128:143], v[172:175], v[204:207], v[128:143]
    v_mov_b32 v95, 0
    v_mov_b32 v96, 0
    v_mov_b32 v97, 0
    ds_read_b64_tr_b16 v[172:173], v224 offset:2976
    ds_read_b64_tr_b16 v[174:175], v224 offset:2944
    s_waitcnt lgkmcnt(6)
    v_mfma_f32_32x32x16_bf16 v[144:159], v[160:163], v[192:195], v[144:159]
    v_mov_b32 v98, 0
    v_mov_b32 v99, 0
    v_mov_b32 v100, 0
    s_waitcnt lgkmcnt(4)
    v_mfma_f32_32x32x16_bf16 v[144:159], v[164:167], v[196:199], v[144:159]
    v_mov_b32 v101, 0
    v_mov_b32 v102, 0
    v_mov_b32 v103, 0
    s_waitcnt lgkmcnt(2)
    v_mfma_f32_32x32x16_bf16 v[144:159], v[168:171], v[200:203], v[144:159]
    s_waitcnt lgkmcnt(0)
    v_mfma_f32_32x32x16_bf16 v[144:159], v[172:175], v[204:207], v[144:159]
    s_nop 1
    ds_write_b128 v226, v[128:131] offset:7056
    ds_write_b128 v226, v[132:135] offset:7088
    ds_write_b128 v226, v[136:139] offset:7120
    ds_write_b128 v226, v[140:143] offset:7152
    s_nop 7
    ds_write_b128 v226, v[144:147] offset:8208
    ds_write_b128 v226, v[148:151] offset:8240
    ds_write_b128 v226, v[152:155] offset:8272
    ds_write_b128 v226, v[156:159] offset:8304
L_conv_done:
    s_cmp_ge_u32 s66, 4
    s_cbranch_scc1 L_kve_done
    s_cmp_ge_u32 s66, 4
    s_cselect_b32 s73, 1024, 0
    v_lshrrev_b32 v14, 5, v1
    v_and_b32 v15, 7, v1
    v_bfe_u32 v16, v1, 3, 2
    v_bfe_u32 v17, v1, 2, 2
    v_bfe_u32 v18, v1, 4, 1
    v_and_b32 v19, 15, v1
    v_lshrrev_b32 v20, 3, v1
    v_add_u32 v231, s73, v2
    v_lshlrev_b32 v22, 4, v19
    v_lshl_add_u32 v22, v14, 8, v22
    s_add_u32 s73, s73, 0x2000
    v_add_u32 v232, s73, v22
    v_lshlrev_b32 v234, 11, v1
    v_lshlrev_b32 v22, 2, v18
    v_xor_b32 v22, v22, v15
    v_lshlrev_b32 v22, 4, v22
    v_lshl_add_u32 v235, v20, 10, v22
    s_lshl_b32 s73, s66, 7
    s_add_u32 s73, s73, 32
    v_add_u32 v22, s73, v1
    v_lshrrev_b32 v24, 5, v22
    v_lshlrev_b32 v22, 2, v22
    v_lshl_add_u32 v22, v24, 4, v22
    v_add_u32 v227, 0x11240, v22
    v_add_u32 v22, s73, v1
    v_subrev_u32 v22, 1, v22
    v_lshrrev_b32 v24, 5, v22
    v_lshlrev_b32 v22, 2, v22
    v_lshl_add_u32 v22, v24, 4, v22
    v_add_u32 v228, 0x13760, v22
    v_add_u32 v22, s73, v1
    v_subrev_u32 v22, 2, v22
    v_lshrrev_b32 v24, 5, v22
    v_lshlrev_b32 v22, 2, v22
    v_lshl_add_u32 v22, v24, 4, v22
    v_add_u32 v229, 0x15c80, v22
    v_add_u32 v22, s73, v1
    v_subrev_u32 v22, 3, v22
    v_lshrrev_b32 v24, 5, v22
    v_lshlrev_b32 v22, 2, v22
    v_lshl_add_u32 v22, v24, 4, v22
    v_add_u32 v230, 0x181a0, v22
    s_lshl_b32 s73, s66, 18
    s_lshl_b32 s74, s72, 1
    s_add_u32 s11, s73, s74
    s_lshr_b32 s73, s73, 1
    s_add_u32 s73, s73, s74
    s_add_u32 s38, s73, 0x200000
    s_and_b32 s73, s65, 7
    s_lshl_b32 s73, s73, 7
    s_lshl_b32 s74, s66, 13
    s_add_u32 s12, s73, s74
    s_lshl_b32 s74, s71, 13
    s_add_u32 s74, s74, s18
    s_and_b32 s75, s66, 3
    s_lshl_b32 s75, s75, 11
    s_add_u32 s74, s74, s75
    s_add_u32 s19, s74, 0x100000
    v_lshrrev_b32 v18, 5, v1
    v_and_b32 v19, 7, v1
    v_bfe_u32 v20, v1, 3, 2
    v_bfe_u32 v21, v1, 2, 2
    v_bfe_u32 v22, v1, 4, 1
    v_lshrrev_b32 v23, 3, v1
    s_and_b32 s73, s66, 3
    s_mul_i32 s73, s73, 0x1800
    s_add_u32 s73, s73, 0x10000
    v_add_u32 v236, s73, v2
    s_and_b32 s73, s66, 1
    s_mul_i32 s73, s73, 0x2640
    s_mul_i32 s74, s39, 0x4c80
    s_add_u32 s73, s73, s74
    s_add_u32 s73, s73, 0x90
    v_mul_u32_u24 v24, 0x990, v20
    v_mul_u32_u24 v26, 0x90, v19
    v_lshl_add_u32 v26, v18, 4, v26
    v_add3_u32 v233, v24, v26, s73
    v_lshl_add_u32 v25, v18, 3, v21
    v_lshlrev_b32 v240, 7, v25
    v_and_b32 v24, 1, v1
    v_lshl_or_b32 v24, v24, 1, v22
    s_and_b32 s73, s66, 2
    s_lshl_b32 s73, s73, 1
    v_or_b32 v24, s73, v24
    v_bfe_u32 v26, v1, 3, 1
    v_lshlrev_b32 v26, 2, v26
    v_xor_b32 v24, v24, v26
    v_lshl_add_u32 v240, v24, 4, v240
    v_bfe_u32 v26, v1, 1, 1
    v_lshl_add_u32 v240, v26, 3, v240
    s_and_b32 s74, s66, 1
    s_lshl_b32 s75, s74, 10
    s_add_u32 s75, s75, 0x10000
    v_add_u32 v238, s75, v2
    s_mul_i32 s74, s74, 0x1200
    s_lshl_b32 s73, s73, 4
    s_add_u32 s73, s73, s74
    s_add_u32 s73, s73, 0x20000
    v_and_b32 v24, 31, v1
    v_mul_u32_u24 v24, 0x90, v24
    v_lshl_add_u32 v24, v18, 5, v24
    v_add_u32 v239, s73, v24
    s_mul_i32 s73, s66, 0x480
    s_add_u32 s73, s73, 0x20000
    v_lshlrev_b32 v24, 4, v19
    v_mul_u32_u24 v26, 0x90, v23
    v_add3_u32 v241, v26, v24, s73
    v_lshl_add_u32 v242, v23, 11, v24
    s_lshl_b32 s16, s71, 5
    s_add_u32 s16, s16, s70
    s_lshl_b32 s16, s16, 7
    s_add_u32 s16, s16, 0xa000
    s_sub_u32 s74, s19, 0x100000
    s_add_u32 s13, s74, 0x700000
    s_lshr_b32 s74, s66, 1
    s_lshl_b32 s74, s74, 6
    s_lshl_b32 s75, s64, 3
    s_add_u32 s74, s74, s75
    s_lshr_b32 s76, s65, 3
    s_lshl_b32 s75, s76, 1
    s_add_u32 s74, s74, s75
    s_and_b32 s75, s66, 1
    s_add_u32 s74, s74, s75
    s_lshl_b32 s74, s74, 10
    s_add_u32 s14, s74, 0x700000
    s_and_b32 s73, s65, 7
    s_lshl_b32 s73, s73, 7
    s_lshl_b32 s74, s64, 2
    s_add_u32 s74, s74, s76
    s_lshl_b32 s74, s74, 3
    s_add_u32 s74, s74, s66
    s_lshl_b32 s74, s74, 14
    s_add_u32 s74, s74, s73
    s_add_u32 s15, s74, 0x400
    s_bitcmp1_b32 s66, 0
    s_cbranch_scc1 L_kve_done
    s_cmp_eq_u32 s66, 0
    s_cbranch_scc0 L_kve_w2
    v_mov_b32 v160, 0
    v_mov_b32 v161, 0
    v_mov_b32 v162, 0
    v_mov_b32 v163, 0
    v_and_b32 v16, 7, v1
    v_mul_u32_u24 v16, 0x2520, v16
    v_bfe_u32 v17, v1, 3, 1
    v_mul_u32_u24 v17, 0x1b90, v17
    v_add_u32 v16, v16, v17
    v_add_u32 v16, 0x112b0, v16
    ds_write_b128 v16, v[160:163]
    s_mov_b32 s78, 0
    s_add_u32 s76, s18, 0x300000
    s_branch L_kve_go
L_kve_w2:
    s_mov_b32 s78, 8192
    s_add_u32 s76, s18, 0x500000
L_kve_go:
    v_lshlrev_b32 v18, 7, v1
    s_mov_b32 s79, 0
    s_mov_b32 exec_hi, 0
L_poll1:
L_poll1_go:
    buffer_load_dword v19, v18, s[48:51], s10 offen sc1
    s_add_u32 s79, s79, 1
    s_waitcnt vmcnt(0)
L_poll1_chk:
    v_cmp_ne_u32 vcc, s67, v19
    s_cmp_gt_u32 s79, 0x4000
    s_cbranch_scc1 L_poll1_done
    s_cmp_lg_u64 vcc, 0
    s_cbranch_scc1 L_poll1
L_poll1_done:
    s_mov_b32 exec_hi, -1
    s_lshl_b32 s73, s97, 13
    s_add_u32 s73, s73, s76
    s_mov_b32 m0, s78
    s_nop 0
    buffer_load_dwordx4 v2, s[48:51], s73 offen offset:0 sc1 lds
    buffer_load_dwordx4 v2, s[48:51], s73 offen offset:1024 sc1 lds
    buffer_load_dwordx4 v2, s[48:51], s73 offen offset:2048 sc1 lds
    buffer_load_dwordx4 v2, s[48:51], s73 offen offset:3072 sc1 lds
    s_add_u32 m0, m0, 0x1000
    s_add_u32 s73, s73, 0x1000
    buffer_load_dwordx4 v2, s[48:51], s73 offen offset:0 sc1 lds
    buffer_load_dwordx4 v2, s[48:51], s73 offen offset:1024 sc1 lds
    buffer_load_dwordx4 v2, s[48:51], s73 offen offset:2048 sc1 lds
    buffer_load_dwordx4 v2, s[48:51], s73 offen offset:3072 sc1 lds
    s_add_u32 s73, s97, 1
    s_and_b32 s73, s73, 7
    s_lshl_b32 s73, s73, 13
    s_add_u32 s73, s73, s76
    s_add_u32 s78, s78, 0x4000
    s_mov_b32 m0, s78
    s_nop 0
    buffer_load_dwordx4 v2, s[48:51], s73 offen offset:0 sc1 lds
    buffer_load_dwordx4 v2, s[48:51], s73 offen offset:1024 sc1 lds
    buffer_load_dwordx4 v2, s[48:51], s73 offen offset:2048 sc1 lds
    buffer_load_dwordx4 v2, s[48:51], s73 offen offset:3072 sc1 lds
    s_add_u32 m0, m0, 0x1000
    s_add_u32 s73, s73, 0x1000
    buffer_load_dwordx4 v2, s[48:51], s73 offen offset:0 sc1 lds
    buffer_load_dwordx4 v2, s[48:51], s73 offen offset:1024 sc1 lds
    buffer_load_dwordx4 v2, s[48:51], s73 offen offset:2048 sc1 lds
    buffer_load_dwordx4 v2, s[48:51], s73 offen offset:3072 sc1 lds
L_kve_done:
    s_waitcnt lgkmcnt(0)
    s_barrier
    buffer_load_dwordx4 v[64:67], v2, s[48:51], s19 offen sc1
    buffer_load_dwordx4 v[68:71], v2, s[48:51], s19 offen offset:1024 sc1
    ds_read_b32 v32, v227 offset:0
    ds_read_b32 v33, v228 offset:0
    ds_read_b32 v34, v229 offset:0
    ds_read_b32 v35, v230 offset:0
    ds_read_b32 v36, v227 offset:38016
    ds_read_b32 v37, v228 offset:38016
    ds_read_b32 v38, v229 offset:38016
    ds_read_b32 v39, v230 offset:38016
    ds_read_b32 v40, v227 offset:288
    ds_read_b32 v41, v228 offset:288
    ds_read_b32 v42, v229 offset:288
    ds_read_b32 v43, v230 offset:288
    s_mul_i32 s73, s66, 0x120
    s_sub_u32 s73, 4608, s73
    s_cmp_eq_u32 s66, 6
    s_cbranch_scc0 L_nocarry
    v_mov_b32 v250, 0
    v_mov_b32 v251, 0
    v_mov_b32 v252, 0
    v_mov_b32 v253, 0
    v_and_b32 v14, 7, v1
    v_mul_u32_u24 v14, 0x2520, v14
    v_bfe_u32 v15, v1, 3, 1
    v_mul_u32_u24 v15, 0x990, v15
    v_add_u32 v14, v14, v15
    v_add_u32 v14, 0x12db0, v14
    s_mov_b64 exec, 0xffff
    ds_read_b128 v[250:253], v14
    s_mov_b64 exec, -1
    s_waitcnt lgkmcnt(0)
L_nocarry:
    s_waitcnt lgkmcnt(8)
    ds_read_b32 v44, v227 offset:38304
    ds_read_b32 v45, v228 offset:38304
    ds_read_b32 v46, v229 offset:38304
    ds_read_b32 v47, v230 offset:38304
    v_add_f32 v32, v32, v33
    v_add_f32 v34, v34, v35
    v_add_f32 v32, v32, v34
    s_waitcnt lgkmcnt(8)
    v_add_u32 v227, s73, v227
    v_add_u32 v228, s73, v228
    v_add_u32 v229, s73, v229
    v_add_u32 v230, s73, v230
    ds_read_b32 v48, v227 offset:0
    ds_read_b32 v49, v228 offset:0
    ds_read_b32 v50, v229 offset:0
    ds_read_b32 v51, v230 offset:0
    v_add_f32 v36, v36, v37
    v_add_f32 v38, v38, v39
    v_add_f32 v36, v36, v38
    v_cvt_pk_bf16_f32 v10, v32, v36
    s_waitcnt lgkmcnt(8)
    ds_read_b32 v52, v227 offset:2448
    ds_read_b32 v53, v228 offset:2448
    ds_read_b32 v54, v229 offset:2448
    ds_read_b32 v55, v230 offset:2448
    v_add_f32 v40, v40, v41
    v_add_f32 v42, v42, v43
    v_add_f32 v40, v40, v42
    s_waitcnt lgkmcnt(8)
    ds_read_b32 v56, v227 offset:38016
    ds_read_b32 v57, v228 offset:38016
    ds_read_b32 v58, v229 offset:38016
    ds_read_b32 v59, v230 offset:38016
    v_add_f32 v44, v44, v45
    v_add_f32 v46, v46, v47
    v_add_f32 v44, v44, v46
    v_cvt_pk_bf16_f32 v11, v40, v44
    s_waitcnt lgkmcnt(8)
    ds_read_b32 v60, v227 offset:40464
    ds_read_b32 v61, v228 offset:40464
    ds_read_b32 v62, v229 offset:40464
    ds_read_b32 v63, v230 offset:40464
    v_add_f32 v48, v48, v49
    v_add_f32 v50, v50, v51
    v_add_f32 v48, v48, v50
    s_waitcnt lgkmcnt(8)
    v_add_f32 v52, v52, v53
    v_add_f32 v54, v54, v55
    v_add_f32 v52, v52, v54
    v_add_f32 v52, v52, v48
    s_waitcnt lgkmcnt(4)
    v_add_f32 v56, v56, v57
    v_add_f32 v58, v58, v59
    v_add_f32 v56, v56, v58
    s_waitcnt lgkmcnt(0)
    v_add_f32 v60, v60, v61
    v_add_f32 v62, v62, v63
    v_add_f32 v60, v60, v62
    v_add_f32 v60, v60, v56
    v_cvt_pk_bf16_f32 v12, v52, v60
    s_waitcnt vmcnt(0)
    s_barrier
    s_cmp_ge_u32 s66, 4
    s_cbranch_scc0 L_kvl_done
    s_and_b32 s74, s66, 3
    s_lshl_b32 s73, s74, 2
    s_add_u32 s73, s73, 0x23b40
    v_mov_b32 v14, s73
    v_mov_b32 v15, 2
    v_mov_b32 v16, 3
    v_mov_b32 v17, 1
    s_lshl_b32 s74, s74, 11
    s_add_u32 s73, s18, s74
    s_add_u32 s75, s97, 2
    s_and_b32 s75, s75, 7
    s_lshl_b32 s75, s75, 13
    s_add_u32 s75, s75, s73
    s_add_u32 m0, s74, 0x8000
    s_add_u32 s76, s75, 0x300000
    buffer_load_dwordx4 v2, s[48:51], s76 offen sc1 lds
    s_add_u32 s77, s75, 0x500000
    buffer_load_dwordx4 v2, s[48:51], s76 offen offset:1024 sc1 lds
    s_add_u32 m0, s74, 0xa000
    s_nop 0
    buffer_load_dwordx4 v2, s[48:51], s77 offen sc1 lds
    buffer_load_dwordx4 v2, s[48:51], s77 offen offset:1024 sc1 lds
    s_add_u32 s75, s97, 3
    s_and_b32 s75, s75, 7
    s_lshl_b32 s75, s75, 13
    s_add_u32 s75, s75, s73
    s_add_u32 m0, s74, 0xc000
    s_add_u32 s76, s75, 0x300000
    buffer_load_dwordx4 v2, s[48:51], s76 offen sc1 lds
    s_add_u32 s77, s75, 0x500000
    buffer_load_dwordx4 v2, s[48:51], s76 offen offset:1024 sc1 lds
    s_add_u32 m0, s74, 0xe000
    s_nop 0
    buffer_load_dwordx4 v2, s[48:51], s77 offen sc1 lds
    buffer_load_dwordx4 v2, s[48:51], s77 offen offset:1024 sc1 lds
    s_add_u32 s75, s97, 4
    s_and_b32 s75, s75, 7
    s_lshl_b32 s75, s75, 13
    s_add_u32 s75, s75, s73
    s_add_u32 m0, s74, 0x10000
    s_add_u32 s76, s75, 0x300000
    buffer_load_dwordx4 v2, s[48:51], s76 offen sc1 lds
    s_add_u32 s77, s75, 0x500000
    buffer_load_dwordx4 v2, s[48:51], s76 offen offset:1024 sc1 lds
    s_add_u32 m0, s74, 0x12000
    s_nop 0
    buffer_load_dwordx4 v2, s[48:51], s77 offen sc1 lds
    buffer_load_dwordx4 v2, s[48:51], s77 offen offset:1024 sc1 lds
    s_add_u32 s75, s97, 5
    s_and_b32 s75, s75, 7
    s_lshl_b32 s75, s75, 13
    s_add_u32 s75, s75, s73
    s_add_u32 m0, s74, 0x14000
    s_add_u32 s76, s75, 0x300000
    buffer_load_dwordx4 v2, s[48:51], s76 offen sc1 lds
    s_add_u32 s77, s75, 0x500000
    buffer_load_dwordx4 v2, s[48:51], s76 offen offset:1024 sc1 lds
    s_add_u32 m0, s74, 0x16000
    s_nop 0
    buffer_load_dwordx4 v2, s[48:51], s77 offen sc1 lds
    buffer_load_dwordx4 v2, s[48:51], s77 offen offset:1024 sc1 lds
    s_waitcnt vmcnt(8)
    ds_write_b32 v14, v15
    s_add_u32 s75, s97, 6
    s_and_b32 s75, s75, 7
    s_lshl_b32 s75, s75, 13
    s_add_u32 s75, s75, s73
    s_add_u32 m0, s74, 0x18000
    s_add_u32 s76, s75, 0x300000
    buffer_load_dwordx4 v2, s[48:51], s76 offen sc1 lds
    s_add_u32 s77, s75, 0x500000
    buffer_load_dwordx4 v2, s[48:51], s76 offen offset:1024 sc1 lds
    s_add_u32 m0, s74, 0x1a000
    s_nop 0
    buffer_load_dwordx4 v2, s[48:51], s77 offen sc1 lds
    buffer_load_dwordx4 v2, s[48:51], s77 offen offset:1024 sc1 lds
    s_add_u32 s75, s97, 7
    s_and_b32 s75, s75, 7
    s_lshl_b32 s75, s75, 13
    s_add_u32 s75, s75, s73
    s_add_u32 m0, s74, 0x1c000
    s_add_u32 s76, s75, 0x300000
    buffer_load_dwordx4 v2, s[48:51], s76 offen sc1 lds
    s_add_u32 s77, s75, 0x500000
    buffer_load_dwordx4 v2, s[48:51], s76 offen offset:1024 sc1 lds
    s_add_u32 m0, s74, 0x1e000
    s_nop 0
    buffer_load_dwordx4 v2, s[48:51], s77 offen sc1 lds
    buffer_load_dwordx4 v2, s[48:51], s77 offen offset:1024 sc1 lds
    v_lshrrev_b32 v18, 5, v1
    v_and_b32 v19, 7, v1
    v_bfe_u32 v20, v1, 3, 2
    v_bfe_u32 v21, v1, 2, 2
    v_bfe_u32 v22, v1, 4, 1
    v_lshrrev_b32 v23, 3, v1
    s_and_b32 s73, s66, 3
    s_mul_i32 s73, s73, 0x1800
    s_add_u32 s73, s73, 0x10000
    v_add_u32 v236, s73, v2
    s_and_b32 s73, s66, 1
    s_mul_i32 s73, s73, 0x2640
    s_mul_i32 s74, s39, 0x4c80
    s_add_u32 s73, s73, s74
    s_add_u32 s73, s73, 0x90
    v_mul_u32_u24 v24, 0x990, v20
    v_mul_u32_u24 v26, 0x90, v19
    v_lshl_add_u32 v26, v18, 4, v26
    v_add3_u32 v233, v24, v26, s73
    v_lshl_add_u32 v25, v18, 3, v21
    v_lshlrev_b32 v240, 7, v25
    v_and_b32 v24, 1, v1
    v_lshl_or_b32 v24, v24, 1, v22
    s_and_b32 s73, s66, 2
    s_lshl_b32 s73, s73, 1
    v_or_b32 v24, s73, v24
    v_bfe_u32 v26, v1, 3, 1
    v_lshlrev_b32 v26, 2, v26
    v_xor_b32 v24, v24, v26
    v_lshl_add_u32 v240, v24, 4, v240
    v_bfe_u32 v26, v1, 1, 1
    v_lshl_add_u32 v240, v26, 3, v240
    s_and_b32 s74, s66, 1
    s_lshl_b32 s75, s74, 10
    s_add_u32 s75, s75, 0x10000
    v_add_u32 v238, s75, v2
    s_mul_i32 s74, s74, 0x1200
    s_lshl_b32 s73, s73, 4
    s_add_u32 s73, s73, s74
    s_add_u32 s73, s73, 0x20000
    v_and_b32 v24, 31, v1
    v_mul_u32_u24 v24, 0x90, v24
    v_lshl_add_u32 v24, v18, 5, v24
    v_add_u32 v239, s73, v24
    s_mul_i32 s73, s66, 0x480
    s_add_u32 s73, s73, 0x20000
    v_lshlrev_b32 v24, 4, v19
    v_mul_u32_u24 v26, 0x90, v23
    v_add3_u32 v241, v26, v24, s73
    v_lshl_add_u32 v242, v23, 11, v24
    s_lshl_b32 s16, s71, 5
    s_add_u32 s16, s16, s70
    s_lshl_b32 s16, s16, 7
    s_add_u32 s16, s16, 0xa000
    s_sub_u32 s74, s19, 0x100000
    s_add_u32 s13, s74, 0x700000
    s_lshr_b32 s74, s66, 1
    s_lshl_b32 s74, s74, 6
    s_lshl_b32 s75, s64, 3
    s_add_u32 s74, s74, s75
    s_lshr_b32 s76, s65, 3
    s_lshl_b32 s75, s76, 1
    s_add_u32 s74, s74, s75
    s_and_b32 s75, s66, 1
    s_add_u32 s74, s74, s75
    s_lshl_b32 s74, s74, 10
    s_add_u32 s14, s74, 0x700000
    s_and_b32 s73, s65, 7
    s_lshl_b32 s73, s73, 7
    s_lshl_b32 s74, s64, 2
    s_add_u32 s74, s74, s76
    s_lshl_b32 s74, s74, 3
    s_add_u32 s74, s74, s66
    s_lshl_b32 s74, s74, 14
    s_add_u32 s74, s74, s73
    s_add_u32 s15, s74, 0x400
    s_waitcnt vmcnt(0) lgkmcnt(0)
    ds_write_b32 v14, v16
L_kvl_done:
    ds_read_b128 v[136:139], v231 offset:0
    ds_read_b128 v[140:143], v231 offset:2048
    s_mov_b64 exec, s[4:5]
    ds_read_b128 v[208:211], v232 offset:0
    ds_read_b128 v[216:219], v232 offset:512
    s_mov_b64 exec, -1
    s_cmp_ge_u32 s66, 4
    s_cbranch_scc1 L_prio1
    s_setprio 2
    s_branch L_prio_done
L_prio1:
    s_setprio 1
L_prio_done:
    s_waitcnt lgkmcnt(3)
    v_mfma_f32_32x32x16_bf16 v[104:119], v[136:139], v[64:67], 0
    s_nop 11
    v_exp_f32 v104, v104
    v_exp_f32 v105, v105
    v_exp_f32 v106, v106
    v_exp_f32 v107, v107
    v_exp_f32 v108, v108
    v_mfma_f32_32x32x16_bf16 v[120:135], v[136:139], v[68:71], 0
    s_waitcnt lgkmcnt(0)
    ds_read_b128 v[136:139], v231 offset:4096
    v_exp_f32 v109, v109
    v_exp_f32 v110, v110
    v_exp_f32 v111, v111
    v_exp_f32 v112, v112
    v_exp_f32 v113, v113
    v_exp_f32 v114, v114
    v_smfmac_f32_32x32x32_bf16 v[72:87], v[208:211], v[104:111], v255
    s_mov_b64 exec, s[4:5]
    ds_read_b128 v[212:215], v232 offset:2048
    ds_read_b128 v[220:223], v232 offset:2560
    s_mov_b64 exec, -1
    v_exp_f32 v115, v115
    v_exp_f32 v116, v116
    v_exp_f32 v117, v117
    v_exp_f32 v118, v118
    v_exp_f32 v119, v119
    v_exp_f32 v120, v120
    v_exp_f32 v121, v121
    v_smfmac_f32_32x32x32_bf16 v[72:87], v[216:219], v[112:119], v255
    v_exp_f32 v122, v122
    v_exp_f32 v123, v123
    v_exp_f32 v124, v124
    v_mfma_f32_32x32x16_bf16 v[104:119], v[140:143], v[64:67], 0
    v_exp_f32 v125, v125
    v_exp_f32 v126, v126
    v_exp_f32 v127, v127
    v_exp_f32 v128, v128
    v_exp_f32 v129, v129
    v_exp_f32 v130, v130
    v_smfmac_f32_32x32x32_bf16 v[88:103], v[208:211], v[120:127], v255
    v_exp_f32 v131, v131
    v_exp_f32 v132, v132
    v_exp_f32 v133, v133
    v_exp_f32 v134, v134
    v_exp_f32 v135, v135
    v_exp_f32 v104, v104
    v_exp_f32 v105, v105
    v_smfmac_f32_32x32x32_bf16 v[88:103], v[216:219], v[128:135], v255
    v_exp_f32 v106, v106
    v_exp_f32 v107, v107
    v_exp_f32 v108, v108
    v_mfma_f32_32x32x16_bf16 v[120:135], v[140:143], v[68:71], 0
    s_waitcnt lgkmcnt(0)
    ds_read_b128 v[140:143], v231 offset:6144
    v_exp_f32 v109, v109
    v_exp_f32 v110, v110
    v_exp_f32 v111, v111
    v_exp_f32 v112, v112
    v_exp_f32 v113, v113
    v_exp_f32 v114, v114
    v_smfmac_f32_32x32x32_bf16 v[72:87], v[212:215], v[104:111], v255
    s_mov_b64 exec, s[4:5]
    ds_read_b128 v[208:211], v232 offset:4096
    ds_read_b128 v[216:219], v232 offset:4608
    s_mov_b64 exec, -1
    v_exp_f32 v115, v115
    v_exp_f32 v116, v116
    v_exp_f32 v117, v117
    v_exp_f32 v118, v118
    v_exp_f32 v119, v119
    v_exp_f32 v120, v120
    v_exp_f32 v121, v121
    v_smfmac_f32_32x32x32_bf16 v[72:87], v[220:223], v[112:119], v255
    v_exp_f32 v122, v122
    v_exp_f32 v123, v123
    v_exp_f32 v124, v124
    v_mfma_f32_32x32x16_bf16 v[104:119], v[136:139], v[64:67], 0
    v_exp_f32 v125, v125
    v_exp_f32 v126, v126
    v_exp_f32 v127, v127
    v_exp_f32 v128, v128
    v_exp_f32 v129, v129
    v_exp_f32 v130, v130
    v_smfmac_f32_32x32x32_bf16 v[88:103], v[212:215], v[120:127], v255
    v_exp_f32 v131, v131
    v_exp_f32 v132, v132
    v_exp_f32 v133, v133
    v_exp_f32 v134, v134
    v_exp_f32 v135, v135
    v_exp_f32 v104, v104
    v_exp_f32 v105, v105
    v_smfmac_f32_32x32x32_bf16 v[88:103], v[220:223], v[128:135], v255
    v_exp_f32 v106, v106
    v_exp_f32 v107, v107
    v_exp_f32 v108, v108
    v_mfma_f32_32x32x16_bf16 v[120:135], v[136:139], v[68:71], 0
    s_waitcnt lgkmcnt(0)
    ds_read_b128 v[136:139], v231 offset:16384
    v_exp_f32 v109, v109
    v_exp_f32 v110, v110
    v_exp_f32 v111, v111
    v_exp_f32 v112, v112
    v_exp_f32 v113, v113
    v_exp_f32 v114, v114
    v_smfmac_f32_32x32x32_bf16 v[72:87], v[208:211], v[104:111], v255
    s_mov_b64 exec, s[4:5]
    ds_read_b128 v[212:215], v232 offset:6144
    ds_read_b128 v[220:223], v232 offset:6656
    s_mov_b64 exec, -1
    v_exp_f32 v115, v115
    v_exp_f32 v116, v116
    v_exp_f32 v117, v117
    v_exp_f32 v118, v118
    v_exp_f32 v119, v119
    v_exp_f32 v120, v120
    v_exp_f32 v121, v121
    v_smfmac_f32_32x32x32_bf16 v[72:87], v[216:219], v[112:119], v255
    v_exp_f32 v122, v122
    v_exp_f32 v123, v123
    v_exp_f32 v124, v124
    v_mfma_f32_32x32x16_bf16 v[104:119], v[140:143], v[64:67], 0
    v_exp_f32 v125, v125
    v_exp_f32 v126, v126
    v_exp_f32 v127, v127
    v_exp_f32 v128, v128
    v_exp_f32 v129, v129
    v_exp_f32 v130, v130
    v_smfmac_f32_32x32x32_bf16 v[88:103], v[208:211], v[120:127], v255
    v_exp_f32 v131, v131
    v_exp_f32 v132, v132
    v_exp_f32 v133, v133
    v_exp_f32 v134, v134
    v_exp_f32 v135, v135
    v_exp_f32 v104, v104
    v_exp_f32 v105, v105
    v_smfmac_f32_32x32x32_bf16 v[88:103], v[216:219], v[128:135], v255
    v_exp_f32 v106, v106
    v_exp_f32 v107, v107
    v_exp_f32 v108, v108
    v_mfma_f32_32x32x16_bf16 v[120:135], v[140:143], v[68:71], 0
    s_waitcnt lgkmcnt(0)
    ds_read_b128 v[140:143], v231 offset:18432
    v_exp_f32 v109, v109
    v_exp_f32 v110, v110
    v_exp_f32 v111, v111
    v_exp_f32 v112, v112
    v_exp_f32 v113, v113
    v_exp_f32 v114, v114
    v_smfmac_f32_32x32x32_bf16 v[72:87], v[212:215], v[104:111], v255
    s_mov_b64 exec, s[4:5]
    ds_read_b128 v[208:211], v232 offset:16384
    ds_read_b128 v[216:219], v232 offset:16896
    s_mov_b64 exec, -1
    v_exp_f32 v115, v115
    v_exp_f32 v116, v116
    v_exp_f32 v117, v117
    v_exp_f32 v118, v118
    v_exp_f32 v119, v119
    v_exp_f32 v120, v120
    v_exp_f32 v121, v121
    v_smfmac_f32_32x32x32_bf16 v[72:87], v[220:223], v[112:119], v255
    v_exp_f32 v122, v122
    v_exp_f32 v123, v123
    v_exp_f32 v124, v124
    v_mfma_f32_32x32x16_bf16 v[104:119], v[136:139], v[64:67], 0
    v_exp_f32 v125, v125
    v_exp_f32 v126, v126
    v_exp_f32 v127, v127
    v_exp_f32 v128, v128
    v_exp_f32 v129, v129
    v_exp_f32 v130, v130
    v_smfmac_f32_32x32x32_bf16 v[88:103], v[212:215], v[120:127], v255
    v_exp_f32 v131, v131
    v_exp_f32 v132, v132
    v_exp_f32 v133, v133
    v_exp_f32 v134, v134
    v_exp_f32 v135, v135
    v_exp_f32 v104, v104
    v_exp_f32 v105, v105
    v_smfmac_f32_32x32x32_bf16 v[88:103], v[220:223], v[128:135], v255
    v_exp_f32 v106, v106
    v_exp_f32 v107, v107
    v_exp_f32 v108, v108
    v_mfma_f32_32x32x16_bf16 v[120:135], v[136:139], v[68:71], 0
    s_waitcnt lgkmcnt(0)
    ds_read_b128 v[136:139], v231 offset:20480
    v_exp_f32 v109, v109
    v_exp_f32 v110, v110
    v_exp_f32 v111, v111
    v_exp_f32 v112, v112
    v_exp_f32 v113, v113
    v_exp_f32 v114, v114
    v_smfmac_f32_32x32x32_bf16 v[72:87], v[208:211], v[104:111], v255
    s_mov_b64 exec, s[4:5]
    ds_read_b128 v[212:215], v232 offset:18432
    ds_read_b128 v[220:223], v232 offset:18944
    s_mov_b64 exec, -1
    v_exp_f32 v115, v115
    v_exp_f32 v116, v116
    v_exp_f32 v117, v117
    v_exp_f32 v118, v118
    v_exp_f32 v119, v119
    v_exp_f32 v120, v120
    v_exp_f32 v121, v121
    v_smfmac_f32_32x32x32_bf16 v[72:87], v[216:219], v[112:119], v255
    v_exp_f32 v122, v122
    v_exp_f32 v123, v123
    v_exp_f32 v124, v124
    v_mfma_f32_32x32x16_bf16 v[104:119], v[140:143], v[64:67], 0
    v_exp_f32 v125, v125
    v_exp_f32 v126, v126
    v_exp_f32 v127, v127
    v_exp_f32 v128, v128
    v_exp_f32 v129, v129
    v_exp_f32 v130, v130
    v_smfmac_f32_32x32x32_bf16 v[88:103], v[208:211], v[120:127], v255
    v_exp_f32 v131, v131
    v_exp_f32 v132, v132
    v_exp_f32 v133, v133
    v_exp_f32 v134, v134
    v_exp_f32 v135, v135
    v_exp_f32 v104, v104
    v_exp_f32 v105, v105
    v_smfmac_f32_32x32x32_bf16 v[88:103], v[216:219], v[128:135], v255
    v_exp_f32 v106, v106
    v_exp_f32 v107, v107
    v_exp_f32 v108, v108
    v_mfma_f32_32x32x16_bf16 v[120:135], v[140:143], v[68:71], 0
    s_waitcnt lgkmcnt(0)
    ds_read_b128 v[140:143], v231 offset:22528
    v_exp_f32 v109, v109
    v_exp_f32 v110, v110
    v_exp_f32 v111, v111
    v_exp_f32 v112, v112
    v_exp_f32 v113, v113
    v_exp_f32 v114, v114
    v_smfmac_f32_32x32x32_bf16 v[72:87], v[212:215], v[104:111], v255
    s_mov_b64 exec, s[4:5]
    ds_read_b128 v[208:211], v232 offset:20480
    ds_read_b128 v[216:219], v232 offset:20992
    s_mov_b64 exec, -1
    v_exp_f32 v115, v115
    v_exp_f32 v116, v116
    v_exp_f32 v117, v117
    v_exp_f32 v118, v118
    v_exp_f32 v119, v119
    v_exp_f32 v120, v120
    v_exp_f32 v121, v121
    v_smfmac_f32_32x32x32_bf16 v[72:87], v[220:223], v[112:119], v255
    v_exp_f32 v122, v122
    v_exp_f32 v123, v123
    v_exp_f32 v124, v124
    v_mfma_f32_32x32x16_bf16 v[104:119], v[136:139], v[64:67], 0
    v_exp_f32 v125, v125
    v_exp_f32 v126, v126
    v_exp_f32 v127, v127
    v_exp_f32 v128, v128
    v_exp_f32 v129, v129
    v_exp_f32 v130, v130
    v_smfmac_f32_32x32x32_bf16 v[88:103], v[212:215], v[120:127], v255
    v_exp_f32 v131, v131
    v_exp_f32 v132, v132
    v_exp_f32 v133, v133
    v_exp_f32 v134, v134
    v_exp_f32 v135, v135
    v_mov_b32 v18, 0x23b40
    s_mov_b32 s76, 0
L_kvchk2:
    ds_read_b128 v[20:23], v18
    s_add_u32 s76, s76, 1
    s_waitcnt lgkmcnt(0)
    v_min_u32 v20, v20, v21
    v_min3_u32 v20, v20, v22, v23
    s_cmp_gt_u32 s76, 0x40000
    s_cbranch_scc1 L_kvchk2_done
    v_readfirstlane_b32 s77, v20
    s_cmp_lt_u32 s77, 2
    s_cbranch_scc1 L_kvchk2
L_kvchk2_done:
    v_exp_f32 v104, v104
    v_exp_f32 v105, v105
    v_smfmac_f32_32x32x32_bf16 v[88:103], v[220:223], v[128:135], v255
    v_exp_f32 v106, v106
    v_exp_f32 v107, v107
    v_exp_f32 v108, v108
    v_mfma_f32_32x32x16_bf16 v[120:135], v[136:139], v[68:71], 0
    s_waitcnt lgkmcnt(0)
    ds_read_b128 v[136:139], v231 offset:32768
    v_exp_f32 v109, v109
    v_exp_f32 v110, v110
    v_exp_f32 v111, v111
    v_exp_f32 v112, v112
    v_exp_f32 v113, v113
    v_exp_f32 v114, v114
    v_smfmac_f32_32x32x32_bf16 v[72:87], v[208:211], v[104:111], v255
    s_mov_b64 exec, s[4:5]
    ds_read_b128 v[212:215], v232 offset:22528
    ds_read_b128 v[220:223], v232 offset:23040
    s_mov_b64 exec, -1
    v_exp_f32 v115, v115
    v_exp_f32 v116, v116
    v_exp_f32 v117, v117
    v_exp_f32 v118, v118
    v_exp_f32 v119, v119
    v_exp_f32 v120, v120
    v_exp_f32 v121, v121
    v_smfmac_f32_32x32x32_bf16 v[72:87], v[216:219], v[112:119], v255
    v_exp_f32 v122, v122
    v_exp_f32 v123, v123
    v_exp_f32 v124, v124
    v_mfma_f32_32x32x16_bf16 v[104:119], v[140:143], v[64:67], 0
    v_exp_f32 v125, v125
    v_exp_f32 v126, v126
    v_exp_f32 v127, v127
    v_exp_f32 v128, v128
    v_exp_f32 v129, v129
    v_exp_f32 v130, v130
    v_smfmac_f32_32x32x32_bf16 v[88:103], v[208:211], v[120:127], v255
    v_exp_f32 v131, v131
    v_exp_f32 v132, v132
    v_exp_f32 v133, v133
    v_exp_f32 v134, v134
    v_exp_f32 v135, v135
    v_exp_f32 v104, v104
    v_exp_f32 v105, v105
    v_smfmac_f32_32x32x32_bf16 v[88:103], v[216:219], v[128:135], v255
    v_exp_f32 v106, v106
    v_exp_f32 v107, v107
    v_exp_f32 v108, v108
    v_mfma_f32_32x32x16_bf16 v[120:135], v[140:143], v[68:71], 0
    s_waitcnt lgkmcnt(0)
    ds_read_b128 v[140:143], v231 offset:34816
    v_exp_f32 v109, v109
    v_exp_f32 v110, v110
    v_exp_f32 v111, v111
    v_exp_f32 v112, v112
    v_exp_f32 v113, v113
    v_exp_f32 v114, v114
    v_smfmac_f32_32x32x32_bf16 v[72:87], v[212:215], v[104:111], v255
    s_mov_b64 exec, s[4:5]
    ds_read_b128 v[208:211], v232 offset:32768
    ds_read_b128 v[216:219], v232 offset:33280
    s_mov_b64 exec, -1
    v_exp_f32 v115, v115
    v_exp_f32 v116, v116
    v_exp_f32 v117, v117
    v_exp_f32 v118, v118
    v_exp_f32 v119, v119
    v_exp_f32 v120, v120
    v_exp_f32 v121, v121
    v_smfmac_f32_32x32x32_bf16 v[72:87], v[220:223], v[112:119], v255
    v_exp_f32 v122, v122
    v_exp_f32 v123, v123
    v_exp_f32 v124, v124
    v_mfma_f32_32x32x16_bf16 v[104:119], v[136:139], v[64:67], 0
    v_exp_f32 v125, v125
    v_exp_f32 v126, v126
    v_exp_f32 v127, v127
    v_exp_f32 v128, v128
    v_exp_f32 v129, v129
    v_exp_f32 v130, v130
    v_smfmac_f32_32x32x32_bf16 v[88:103], v[212:215], v[120:127], v255
    v_exp_f32 v131, v131
    v_exp_f32 v132, v132
    v_exp_f32 v133, v133
    v_exp_f32 v134, v134
    v_exp_f32 v135, v135
    v_exp_f32 v104, v104
    v_exp_f32 v105, v105
    v_smfmac_f32_32x32x32_bf16 v[88:103], v[220:223], v[128:135], v255
    v_exp_f32 v106, v106
    v_exp_f32 v107, v107
    v_exp_f32 v108, v108
    v_mfma_f32_32x32x16_bf16 v[120:135], v[136:139], v[68:71], 0
    s_waitcnt lgkmcnt(0)
    ds_read_b128 v[136:139], v231 offset:36864
    v_exp_f32 v109, v109
    v_exp_f32 v110, v110
    v_exp_f32 v111, v111
    v_exp_f32 v112, v112
    v_exp_f32 v113, v113
    v_exp_f32 v114, v114
    v_smfmac_f32_32x32x32_bf16 v[72:87], v[208:211], v[104:111], v255
    s_mov_b64 exec, s[4:5]
    ds_read_b128 v[212:215], v232 offset:34816
    ds_read_b128 v[220:223], v232 offset:35328
    s_mov_b64 exec, -1
    v_exp_f32 v115, v115
    v_exp_f32 v116, v116
    v_exp_f32 v117, v117
    v_exp_f32 v118, v118
    v_exp_f32 v119, v119
    v_exp_f32 v120, v120
    v_exp_f32 v121, v121
    v_smfmac_f32_32x32x32_bf16 v[72:87], v[216:219], v[112:119], v255
    v_exp_f32 v122, v122
    v_exp_f32 v123, v123
    v_exp_f32 v124, v124
    v_mfma_f32_32x32x16_bf16 v[104:119], v[140:143], v[64:67], 0
    v_exp_f32 v125, v125
    v_exp_f32 v126, v126
    v_exp_f32 v127, v127
    v_exp_f32 v128, v128
    v_exp_f32 v129, v129
    v_exp_f32 v130, v130
    v_smfmac_f32_32x32x32_bf16 v[88:103], v[208:211], v[120:127], v255
    v_exp_f32 v131, v131
    v_exp_f32 v132, v132
    v_exp_f32 v133, v133
    v_exp_f32 v134, v134
    v_exp_f32 v135, v135
    v_exp_f32 v104, v104
    v_exp_f32 v105, v105
    v_smfmac_f32_32x32x32_bf16 v[88:103], v[216:219], v[128:135], v255
    v_exp_f32 v106, v106
    v_exp_f32 v107, v107
    v_exp_f32 v108, v108
    v_mfma_f32_32x32x16_bf16 v[120:135], v[140:143], v[68:71], 0
    s_waitcnt lgkmcnt(0)
    ds_read_b128 v[140:143], v231 offset:38912
    v_exp_f32 v109, v109
    v_exp_f32 v110, v110
    v_exp_f32 v111, v111
    v_exp_f32 v112, v112
    v_exp_f32 v113, v113
    v_exp_f32 v114, v114
    v_smfmac_f32_32x32x32_bf16 v[72:87], v[212:215], v[104:111], v255
    s_mov_b64 exec, s[4:5]
    ds_read_b128 v[208:211], v232 offset:36864
    ds_read_b128 v[216:219], v232 offset:37376
    s_mov_b64 exec, -1
    v_exp_f32 v115, v115
    v_exp_f32 v116, v116
    v_exp_f32 v117, v117
    v_exp_f32 v118, v118
    v_exp_f32 v119, v119
    v_exp_f32 v120, v120
    v_exp_f32 v121, v121
    v_smfmac_f32_32x32x32_bf16 v[72:87], v[220:223], v[112:119], v255
    v_exp_f32 v122, v122
    v_exp_f32 v123, v123
    v_exp_f32 v124, v124
    v_mfma_f32_32x32x16_bf16 v[104:119], v[136:139], v[64:67], 0
    v_exp_f32 v125, v125
    v_exp_f32 v126, v126
    v_exp_f32 v127, v127
    v_exp_f32 v128, v128
    v_exp_f32 v129, v129
    v_exp_f32 v130, v130
    v_smfmac_f32_32x32x32_bf16 v[88:103], v[212:215], v[120:127], v255
    v_exp_f32 v131, v131
    v_exp_f32 v132, v132
    v_exp_f32 v133, v133
    v_exp_f32 v134, v134
    v_exp_f32 v135, v135
    v_exp_f32 v104, v104
    v_exp_f32 v105, v105
    v_smfmac_f32_32x32x32_bf16 v[88:103], v[220:223], v[128:135], v255
    v_exp_f32 v106, v106
    v_exp_f32 v107, v107
    v_exp_f32 v108, v108
    v_mfma_f32_32x32x16_bf16 v[120:135], v[136:139], v[68:71], 0
    s_waitcnt lgkmcnt(0)
    ds_read_b128 v[136:139], v231 offset:49152
    v_exp_f32 v109, v109
    v_exp_f32 v110, v110
    v_exp_f32 v111, v111
    v_exp_f32 v112, v112
    v_exp_f32 v113, v113
    v_exp_f32 v114, v114
    v_smfmac_f32_32x32x32_bf16 v[72:87], v[208:211], v[104:111], v255
    s_mov_b64 exec, s[4:5]
    ds_read_b128 v[212:215], v232 offset:38912
    ds_read_b128 v[220:223], v232 offset:39424
    s_mov_b64 exec, -1
    v_exp_f32 v115, v115
    v_exp_f32 v116, v116
    v_exp_f32 v117, v117
    v_exp_f32 v118, v118
    v_exp_f32 v119, v119
    v_exp_f32 v120, v120
    v_exp_f32 v121, v121
    v_smfmac_f32_32x32x32_bf16 v[72:87], v[216:219], v[112:119], v255
    v_exp_f32 v122, v122
    v_exp_f32 v123, v123
    v_exp_f32 v124, v124
    v_mfma_f32_32x32x16_bf16 v[104:119], v[140:143], v[64:67], 0
    v_exp_f32 v125, v125
    v_exp_f32 v126, v126
    v_exp_f32 v127, v127
    v_exp_f32 v128, v128
    v_exp_f32 v129, v129
    v_exp_f32 v130, v130
    v_smfmac_f32_32x32x32_bf16 v[88:103], v[208:211], v[120:127], v255
    v_exp_f32 v131, v131
    v_exp_f32 v132, v132
    v_exp_f32 v133, v133
    v_exp_f32 v134, v134
    v_exp_f32 v135, v135
    v_exp_f32 v104, v104
    v_exp_f32 v105, v105
    v_smfmac_f32_32x32x32_bf16 v[88:103], v[216:219], v[128:135], v255
    v_exp_f32 v106, v106
    v_exp_f32 v107, v107
    v_exp_f32 v108, v108
    v_mfma_f32_32x32x16_bf16 v[120:135], v[140:143], v[68:71], 0
    s_waitcnt lgkmcnt(0)
    v_add_u32 v231, 0xc000, v231
    v_add_u32 v232, 0xc000, v232
    ds_read_b128 v[140:143], v231 offset:2048
    v_exp_f32 v109, v109
    v_exp_f32 v110, v110
    v_exp_f32 v111, v111
    v_exp_f32 v112, v112
    v_exp_f32 v113, v113
    v_exp_f32 v114, v114
    v_smfmac_f32_32x32x32_bf16 v[72:87], v[212:215], v[104:111], v255
    s_mov_b64 exec, s[4:5]
    ds_read_b128 v[208:211], v232 offset:0
    ds_read_b128 v[216:219], v232 offset:512
    s_mov_b64 exec, -1
    v_exp_f32 v115, v115
    v_exp_f32 v116, v116
    v_exp_f32 v117, v117
    v_exp_f32 v118, v118
    v_exp_f32 v119, v119
    v_exp_f32 v120, v120
    v_exp_f32 v121, v121
    v_smfmac_f32_32x32x32_bf16 v[72:87], v[220:223], v[112:119], v255
    v_exp_f32 v122, v122
    v_exp_f32 v123, v123
    v_exp_f32 v124, v124
    v_mfma_f32_32x32x16_bf16 v[104:119], v[136:139], v[64:67], 0
    v_exp_f32 v125, v125
    v_exp_f32 v126, v126
    v_exp_f32 v127, v127
    v_exp_f32 v128, v128
    v_exp_f32 v129, v129
    v_exp_f32 v130, v130
    v_smfmac_f32_32x32x32_bf16 v[88:103], v[212:215], v[120:127], v255
    v_exp_f32 v131, v131
    v_exp_f32 v132, v132
    v_exp_f32 v133, v133
    v_exp_f32 v134, v134
    v_exp_f32 v135, v135
    v_exp_f32 v104, v104
    v_exp_f32 v105, v105
    v_smfmac_f32_32x32x32_bf16 v[88:103], v[220:223], v[128:135], v255
    v_exp_f32 v106, v106
    v_exp_f32 v107, v107
    v_exp_f32 v108, v108
    v_mfma_f32_32x32x16_bf16 v[120:135], v[136:139], v[68:71], 0
    s_waitcnt lgkmcnt(0)
    ds_read_b128 v[136:139], v231 offset:4096
    v_exp_f32 v109, v109
    v_exp_f32 v110, v110
    v_exp_f32 v111, v111
    v_exp_f32 v112, v112
    v_exp_f32 v113, v113
    v_exp_f32 v114, v114
    v_smfmac_f32_32x32x32_bf16 v[72:87], v[208:211], v[104:111], v255
    s_mov_b64 exec, s[4:5]
    ds_read_b128 v[212:215], v232 offset:2048
    ds_read_b128 v[220:223], v232 offset:2560
    s_mov_b64 exec, -1
    v_exp_f32 v115, v115
    v_exp_f32 v116, v116
    v_exp_f32 v117, v117
    v_exp_f32 v118, v118
    v_exp_f32 v119, v119
    v_exp_f32 v120, v120
    v_exp_f32 v121, v121
    v_smfmac_f32_32x32x32_bf16 v[72:87], v[216:219], v[112:119], v255
    v_exp_f32 v122, v122
    v_exp_f32 v123, v123
    v_exp_f32 v124, v124
    v_mfma_f32_32x32x16_bf16 v[104:119], v[140:143], v[64:67], 0
    v_exp_f32 v125, v125
    v_exp_f32 v126, v126
    v_exp_f32 v127, v127
    v_exp_f32 v128, v128
    v_exp_f32 v129, v129
    v_exp_f32 v130, v130
    v_smfmac_f32_32x32x32_bf16 v[88:103], v[208:211], v[120:127], v255
    v_exp_f32 v131, v131
    v_exp_f32 v132, v132
    v_exp_f32 v133, v133
    v_exp_f32 v134, v134
    v_exp_f32 v135, v135
    s_cmp_ge_u32 s66, 4
    s_cbranch_scc1 L_noflip13
    s_setprio 0
L_noflip13:
    v_exp_f32 v104, v104
    v_exp_f32 v105, v105
    v_smfmac_f32_32x32x32_bf16 v[88:103], v[216:219], v[128:135], v255
    v_exp_f32 v106, v106
    v_exp_f32 v107, v107
    v_exp_f32 v108, v108
    v_mfma_f32_32x32x16_bf16 v[120:135], v[140:143], v[68:71], 0
    s_waitcnt lgkmcnt(0)
    ds_read_b128 v[140:143], v231 offset:6144
    v_exp_f32 v109, v109
    v_exp_f32 v110, v110
    v_exp_f32 v111, v111
    v_exp_f32 v112, v112
    v_exp_f32 v113, v113
    v_exp_f32 v114, v114
    v_smfmac_f32_32x32x32_bf16 v[72:87], v[212:215], v[104:111], v255
    s_mov_b64 exec, s[4:5]
    ds_read_b128 v[208:211], v232 offset:4096
    ds_read_b128 v[216:219], v232 offset:4608
    s_mov_b64 exec, -1
    v_exp_f32 v115, v115
    v_exp_f32 v116, v116
    v_exp_f32 v117, v117
    v_exp_f32 v118, v118
    v_exp_f32 v119, v119
    v_exp_f32 v120, v120
    v_exp_f32 v121, v121
    v_smfmac_f32_32x32x32_bf16 v[72:87], v[220:223], v[112:119], v255
    v_exp_f32 v122, v122
    v_exp_f32 v123, v123
    v_exp_f32 v124, v124
    v_mfma_f32_32x32x16_bf16 v[104:119], v[136:139], v[64:67], 0
    v_exp_f32 v125, v125
    v_exp_f32 v126, v126
    v_exp_f32 v127, v127
    v_exp_f32 v128, v128
    v_exp_f32 v129, v129
    v_exp_f32 v130, v130
    v_smfmac_f32_32x32x32_bf16 v[88:103], v[212:215], v[120:127], v255
    v_exp_f32 v131, v131
    v_exp_f32 v132, v132
    v_exp_f32 v133, v133
    v_exp_f32 v134, v134
    v_exp_f32 v135, v135
    v_mov_b32 v18, 0x23b40
    s_mov_b32 s76, 0
L_kvchk3:
    ds_read_b128 v[20:23], v18
    s_add_u32 s76, s76, 1
    s_waitcnt lgkmcnt(0)
    v_min_u32 v20, v20, v21
    v_min3_u32 v20, v20, v22, v23
    s_cmp_gt_u32 s76, 0x40000
    s_cbranch_scc1 L_kvchk3_done
    v_readfirstlane_b32 s77, v20
    s_cmp_lt_u32 s77, 3
    s_cbranch_scc1 L_kvchk3
L_kvchk3_done:
    v_exp_f32 v104, v104
    v_exp_f32 v105, v105
    v_smfmac_f32_32x32x32_bf16 v[88:103], v[220:223], v[128:135], v255
    v_exp_f32 v106, v106
    v_exp_f32 v107, v107
    v_exp_f32 v108, v108
    v_mfma_f32_32x32x16_bf16 v[120:135], v[136:139], v[68:71], 0
    s_waitcnt lgkmcnt(0)
    ds_read_b128 v[136:139], v231 offset:16384
    v_exp_f32 v109, v109
    v_exp_f32 v110, v110
    v_exp_f32 v111, v111
    v_exp_f32 v112, v112
    v_exp_f32 v113, v113
    v_exp_f32 v114, v114
    v_smfmac_f32_32x32x32_bf16 v[72:87], v[208:211], v[104:111], v255
    s_mov_b64 exec, s[4:5]
    ds_read_b128 v[212:215], v232 offset:6144
    ds_read_b128 v[220:223], v232 offset:6656
    s_mov_b64 exec, -1
    v_exp_f32 v115, v115
    v_exp_f32 v116, v116
    v_exp_f32 v117, v117
    v_exp_f32 v118, v118
    v_exp_f32 v119, v119
    v_exp_f32 v120, v120
    v_exp_f32 v121, v121
    v_smfmac_f32_32x32x32_bf16 v[72:87], v[216:219], v[112:119], v255
    v_exp_f32 v122, v122
    v_exp_f32 v123, v123
    v_exp_f32 v124, v124
    v_mfma_f32_32x32x16_bf16 v[104:119], v[140:143], v[64:67], 0
    v_exp_f32 v125, v125
    v_exp_f32 v126, v126
    v_exp_f32 v127, v127
    v_exp_f32 v128, v128
    v_exp_f32 v129, v129
    v_exp_f32 v130, v130
    v_smfmac_f32_32x32x32_bf16 v[88:103], v[208:211], v[120:127], v255
    v_exp_f32 v131, v131
    v_exp_f32 v132, v132
    v_exp_f32 v133, v133
    v_exp_f32 v134, v134
    v_exp_f32 v135, v135
    v_exp_f32 v104, v104
    v_exp_f32 v105, v105
    v_smfmac_f32_32x32x32_bf16 v[88:103], v[216:219], v[128:135], v255
    v_exp_f32 v106, v106
    v_exp_f32 v107, v107
    v_exp_f32 v108, v108
    v_mfma_f32_32x32x16_bf16 v[120:135], v[140:143], v[68:71], 0
    s_waitcnt lgkmcnt(0)
    ds_read_b128 v[140:143], v231 offset:18432
    buffer_store_dword v10, v234, s[56:59], s11 offen
    s_add_u32 s11, s11, 0x20000
    v_exp_f32 v109, v109
    v_exp_f32 v110, v110
    v_exp_f32 v111, v111
    v_exp_f32 v112, v112
    v_exp_f32 v113, v113
    v_exp_f32 v114, v114
    v_smfmac_f32_32x32x32_bf16 v[72:87], v[212:215], v[104:111], v255
    s_mov_b64 exec, s[4:5]
    ds_read_b128 v[208:211], v232 offset:16384
    ds_read_b128 v[216:219], v232 offset:16896
    s_mov_b64 exec, -1
    v_exp_f32 v115, v115
    v_exp_f32 v116, v116
    v_exp_f32 v117, v117
    v_exp_f32 v118, v118
    v_exp_f32 v119, v119
    v_exp_f32 v120, v120
    v_exp_f32 v121, v121
    v_smfmac_f32_32x32x32_bf16 v[72:87], v[220:223], v[112:119], v255
    v_exp_f32 v122, v122
    v_exp_f32 v123, v123
    v_exp_f32 v124, v124
    v_mfma_f32_32x32x16_bf16 v[104:119], v[136:139], v[64:67], 0
    v_exp_f32 v125, v125
    v_exp_f32 v126, v126
    v_exp_f32 v127, v127
    v_exp_f32 v128, v128
    v_exp_f32 v129, v129
    v_exp_f32 v130, v130
    v_smfmac_f32_32x32x32_bf16 v[88:103], v[212:215], v[120:127], v255
    v_exp_f32 v131, v131
    v_exp_f32 v132, v132
    v_exp_f32 v133, v133
    v_exp_f32 v134, v134
    v_exp_f32 v135, v135
    s_barrier
    s_cmp_ge_u32 s66, 4
    s_cbranch_scc1 L_noflip16
    s_setprio 2
L_noflip16:
    v_exp_f32 v104, v104
    v_exp_f32 v105, v105
    v_smfmac_f32_32x32x32_bf16 v[88:103], v[220:223], v[128:135], v255
    v_exp_f32 v106, v106
    v_exp_f32 v107, v107
    v_exp_f32 v108, v108
    v_mfma_f32_32x32x16_bf16 v[120:135], v[136:139], v[68:71], 0
    s_waitcnt lgkmcnt(0)
    ds_read_b128 v[136:139], v231 offset:20480
    v_exp_f32 v109, v109
    v_exp_f32 v110, v110
    v_exp_f32 v111, v111
    v_exp_f32 v112, v112
    v_exp_f32 v113, v113
    v_exp_f32 v114, v114
    v_smfmac_f32_32x32x32_bf16 v[72:87], v[208:211], v[104:111], v255
    s_mov_b64 exec, s[4:5]
    ds_read_b128 v[212:215], v232 offset:18432
    ds_read_b128 v[220:223], v232 offset:18944
    s_mov_b64 exec, -1
    v_exp_f32 v115, v115
    v_exp_f32 v116, v116
    v_exp_f32 v117, v117
    v_exp_f32 v118, v118
    v_exp_f32 v119, v119
    v_exp_f32 v120, v120
    v_exp_f32 v121, v121
    v_smfmac_f32_32x32x32_bf16 v[72:87], v[216:219], v[112:119], v255
    v_exp_f32 v122, v122
    v_exp_f32 v123, v123
    v_exp_f32 v124, v124
    v_mfma_f32_32x32x16_bf16 v[104:119], v[140:143], v[64:67], 0
    v_exp_f32 v125, v125
    v_exp_f32 v126, v126
    v_exp_f32 v127, v127
    v_exp_f32 v128, v128
    v_exp_f32 v129, v129
    v_exp_f32 v130, v130
    v_smfmac_f32_32x32x32_bf16 v[88:103], v[208:211], v[120:127], v255
    v_exp_f32 v131, v131
    v_exp_f32 v132, v132
    v_exp_f32 v133, v133
    v_exp_f32 v134, v134
    v_exp_f32 v135, v135
    v_exp_f32 v104, v104
    v_exp_f32 v105, v105
    v_smfmac_f32_32x32x32_bf16 v[88:103], v[216:219], v[128:135], v255
    v_exp_f32 v106, v106
    v_exp_f32 v107, v107
    v_exp_f32 v108, v108
    v_mfma_f32_32x32x16_bf16 v[120:135], v[140:143], v[68:71], 0
    s_waitcnt lgkmcnt(0)
    ds_read_b128 v[140:143], v231 offset:22528
    s_add_u32 m0, s3, 0
    s_nop 0
    buffer_load_dwordx4 v235, s[60:63], s12 offen lds
    v_exp_f32 v109, v109
    v_exp_f32 v110, v110
    v_exp_f32 v111, v111
    v_exp_f32 v112, v112
    v_exp_f32 v113, v113
    v_exp_f32 v114, v114
    v_smfmac_f32_32x32x32_bf16 v[72:87], v[212:215], v[104:111], v255
    s_mov_b64 exec, s[4:5]
    ds_read_b128 v[208:211], v232 offset:20480
    ds_read_b128 v[216:219], v232 offset:20992
    s_mov_b64 exec, -1
    v_exp_f32 v115, v115
    v_exp_f32 v116, v116
    v_exp_f32 v117, v117
    v_exp_f32 v118, v118
    v_exp_f32 v119, v119
    v_exp_f32 v120, v120
    v_exp_f32 v121, v121
    v_smfmac_f32_32x32x32_bf16 v[72:87], v[220:223], v[112:119], v255
    v_exp_f32 v122, v122
    v_exp_f32 v123, v123
    v_exp_f32 v124, v124
    v_mfma_f32_32x32x16_bf16 v[104:119], v[136:139], v[64:67], 0
    v_exp_f32 v125, v125
    v_exp_f32 v126, v126
    v_exp_f32 v127, v127
    v_exp_f32 v128, v128
    v_exp_f32 v129, v129
    v_exp_f32 v130, v130
    v_smfmac_f32_32x32x32_bf16 v[88:103], v[212:215], v[120:127], v255
    v_exp_f32 v131, v131
    v_exp_f32 v132, v132
    v_exp_f32 v133, v133
    v_exp_f32 v134, v134
    v_exp_f32 v135, v135
    v_exp_f32 v104, v104
    v_exp_f32 v105, v105
    v_smfmac_f32_32x32x32_bf16 v[88:103], v[220:223], v[128:135], v255
    v_exp_f32 v106, v106
    v_exp_f32 v107, v107
    v_exp_f32 v108, v108
    v_mfma_f32_32x32x16_bf16 v[120:135], v[136:139], v[68:71], 0
    s_waitcnt lgkmcnt(0)
    ds_read_b128 v[136:139], v231 offset:32768
    s_add_u32 m0, s3, 0x2000
    s_add_u32 s12, s12, 0x10000
    buffer_load_dwordx4 v235, s[60:63], s12 offen lds
    v_exp_f32 v109, v109
    v_exp_f32 v110, v110
    v_exp_f32 v111, v111
    v_exp_f32 v112, v112
    v_exp_f32 v113, v113
    v_exp_f32 v114, v114
    v_smfmac_f32_32x32x32_bf16 v[72:87], v[208:211], v[104:111], v255
    s_mov_b64 exec, s[4:5]
    ds_read_b128 v[212:215], v232 offset:22528
    ds_read_b128 v[220:223], v232 offset:23040
    s_mov_b64 exec, -1
    v_exp_f32 v115, v115
    v_exp_f32 v116, v116
    v_exp_f32 v117, v117
    v_exp_f32 v118, v118
    v_exp_f32 v119, v119
    v_exp_f32 v120, v120
    v_exp_f32 v121, v121
    v_smfmac_f32_32x32x32_bf16 v[72:87], v[216:219], v[112:119], v255
    v_exp_f32 v122, v122
    v_exp_f32 v123, v123
    v_exp_f32 v124, v124
    v_mfma_f32_32x32x16_bf16 v[104:119], v[140:143], v[64:67], 0
    v_exp_f32 v125, v125
    v_exp_f32 v126, v126
    v_exp_f32 v127, v127
    v_exp_f32 v128, v128
    v_exp_f32 v129, v129
    v_exp_f32 v130, v130
    v_smfmac_f32_32x32x32_bf16 v[88:103], v[208:211], v[120:127], v255
    v_exp_f32 v131, v131
    v_exp_f32 v132, v132
    v_exp_f32 v133, v133
    v_exp_f32 v134, v134
    v_exp_f32 v135, v135
    v_exp_f32 v104, v104
    v_exp_f32 v105, v105
    v_smfmac_f32_32x32x32_bf16 v[88:103], v[216:219], v[128:135], v255
    v_exp_f32 v106, v106
    v_exp_f32 v107, v107
    v_exp_f32 v108, v108
    v_mfma_f32_32x32x16_bf16 v[120:135], v[140:143], v[68:71], 0
    s_waitcnt lgkmcnt(0)
    ds_read_b128 v[140:143], v231 offset:34816
    s_add_u32 m0, s3, 0x4000
    s_add_u32 s12, s12, 0x10000
    buffer_load_dwordx4 v235, s[60:63], s12 offen lds
    v_exp_f32 v109, v109
    v_exp_f32 v110, v110
    v_exp_f32 v111, v111
    v_exp_f32 v112, v112
    v_exp_f32 v113, v113
    v_exp_f32 v114, v114
    v_smfmac_f32_32x32x32_bf16 v[72:87], v[212:215], v[104:111], v255
    s_mov_b64 exec, s[4:5]
    ds_read_b128 v[208:211], v232 offset:32768
    ds_read_b128 v[216:219], v232 offset:33280
    s_mov_b64 exec, -1
    v_exp_f32 v115, v115
    v_exp_f32 v116, v116
    v_exp_f32 v117, v117
    v_exp_f32 v118, v118
    v_exp_f32 v119, v119
    v_exp_f32 v120, v120
    v_exp_f32 v121, v121
    v_smfmac_f32_32x32x32_bf16 v[72:87], v[220:223], v[112:119], v255
    v_exp_f32 v122, v122
    v_exp_f32 v123, v123
    v_exp_f32 v124, v124
    v_mfma_f32_32x32x16_bf16 v[104:119], v[136:139], v[64:67], 0
    v_exp_f32 v125, v125
    v_exp_f32 v126, v126
    v_exp_f32 v127, v127
    v_exp_f32 v128, v128
    v_exp_f32 v129, v129
    v_exp_f32 v130, v130
    v_smfmac_f32_32x32x32_bf16 v[88:103], v[212:215], v[120:127], v255
    v_exp_f32 v131, v131
    v_exp_f32 v132, v132
    v_exp_f32 v133, v133
    v_exp_f32 v134, v134
    v_exp_f32 v135, v135
    v_exp_f32 v104, v104
    v_exp_f32 v105, v105
    v_smfmac_f32_32x32x32_bf16 v[88:103], v[220:223], v[128:135], v255
    v_exp_f32 v106, v106
    v_exp_f32 v107, v107
    v_exp_f32 v108, v108
    v_mfma_f32_32x32x16_bf16 v[120:135], v[136:139], v[68:71], 0
    s_waitcnt lgkmcnt(0)
    ds_read_b128 v[136:139], v231 offset:36864
    buffer_store_dword v11, v234, s[56:59], s11 offen
    v_exp_f32 v109, v109
    v_exp_f32 v110, v110
    v_exp_f32 v111, v111
    v_exp_f32 v112, v112
    v_exp_f32 v113, v113
    v_exp_f32 v114, v114
    v_smfmac_f32_32x32x32_bf16 v[72:87], v[208:211], v[104:111], v255
    s_mov_b64 exec, s[4:5]
    ds_read_b128 v[212:215], v232 offset:34816
    ds_read_b128 v[220:223], v232 offset:35328
    s_mov_b64 exec, -1
    v_exp_f32 v115, v115
    v_exp_f32 v116, v116
    v_exp_f32 v117, v117
    v_exp_f32 v118, v118
    v_exp_f32 v119, v119
    v_exp_f32 v120, v120
    v_exp_f32 v121, v121
    v_smfmac_f32_32x32x32_bf16 v[72:87], v[216:219], v[112:119], v255
    v_exp_f32 v122, v122
    v_exp_f32 v123, v123
    v_exp_f32 v124, v124
    v_mfma_f32_32x32x16_bf16 v[104:119], v[140:143], v[64:67], 0
    v_exp_f32 v125, v125
    v_exp_f32 v126, v126
    v_exp_f32 v127, v127
    v_exp_f32 v128, v128
    v_exp_f32 v129, v129
    v_exp_f32 v130, v130
    v_smfmac_f32_32x32x32_bf16 v[88:103], v[208:211], v[120:127], v255
    v_exp_f32 v131, v131
    v_exp_f32 v132, v132
    v_exp_f32 v133, v133
    v_exp_f32 v134, v134
    v_exp_f32 v135, v135
    v_exp_f32 v104, v104
    v_exp_f32 v105, v105
    v_smfmac_f32_32x32x32_bf16 v[88:103], v[216:219], v[128:135], v255
    v_exp_f32 v106, v106
    v_exp_f32 v107, v107
    v_exp_f32 v108, v108
    v_mfma_f32_32x32x16_bf16 v[120:135], v[140:143], v[68:71], 0
    s_waitcnt lgkmcnt(0)
    ds_read_b128 v[140:143], v231 offset:38912
    s_add_u32 m0, s3, 0x6000
    s_add_u32 s12, s12, 0x10000
    buffer_load_dwordx4 v235, s[60:63], s12 offen lds
    v_exp_f32 v109, v109
    v_exp_f32 v110, v110
    v_exp_f32 v111, v111
    v_exp_f32 v112, v112
    v_exp_f32 v113, v113
    v_exp_f32 v114, v114
    v_smfmac_f32_32x32x32_bf16 v[72:87], v[212:215], v[104:111], v255
    s_mov_b64 exec, s[4:5]
    ds_read_b128 v[208:211], v232 offset:36864
    ds_read_b128 v[216:219], v232 offset:37376
    s_mov_b64 exec, -1
    v_exp_f32 v115, v115
    v_exp_f32 v116, v116
    v_exp_f32 v117, v117
    v_exp_f32 v118, v118
    v_exp_f32 v119, v119
    v_exp_f32 v120, v120
    v_exp_f32 v121, v121
    v_smfmac_f32_32x32x32_bf16 v[72:87], v[220:223], v[112:119], v255
    v_exp_f32 v122, v122
    v_exp_f32 v123, v123
    v_exp_f32 v124, v124
    v_mfma_f32_32x32x16_bf16 v[104:119], v[136:139], v[64:67], 0
    v_exp_f32 v125, v125
    v_exp_f32 v126, v126
    v_exp_f32 v127, v127
    v_exp_f32 v128, v128
    v_exp_f32 v129, v129
    v_exp_f32 v130, v130
    v_smfmac_f32_32x32x32_bf16 v[88:103], v[212:215], v[120:127], v255
    v_exp_f32 v131, v131
    v_exp_f32 v132, v132
    v_exp_f32 v133, v133
    v_exp_f32 v134, v134
    v_exp_f32 v135, v135
    v_exp_f32 v104, v104
    v_exp_f32 v105, v105
    v_smfmac_f32_32x32x32_bf16 v[88:103], v[220:223], v[128:135], v255
    v_exp_f32 v106, v106
    v_exp_f32 v107, v107
    v_exp_f32 v108, v108
    v_mfma_f32_32x32x16_bf16 v[120:135], v[136:139], v[68:71], 0
    s_waitcnt lgkmcnt(0)
    ds_read_b128 v[136:139], v231 offset:49152
    s_add_u32 m0, s3, 0x8000
    s_add_u32 s12, s12, 0x10000
    buffer_load_dwordx4 v235, s[60:63], s12 offen lds
    v_exp_f32 v109, v109
    v_exp_f32 v110, v110
    v_exp_f32 v111, v111
    v_exp_f32 v112, v112
    v_exp_f32 v113, v113
    v_exp_f32 v114, v114
    v_smfmac_f32_32x32x32_bf16 v[72:87], v[208:211], v[104:111], v255
    s_mov_b64 exec, s[4:5]
    ds_read_b128 v[212:215], v232 offset:38912
    ds_read_b128 v[220:223], v232 offset:39424
    s_mov_b64 exec, -1
    v_exp_f32 v115, v115
    v_exp_f32 v116, v116
    v_exp_f32 v117, v117
    v_exp_f32 v118, v118
    v_exp_f32 v119, v119
    v_exp_f32 v120, v120
    v_exp_f32 v121, v121
    v_smfmac_f32_32x32x32_bf16 v[72:87], v[216:219], v[112:119], v255
    v_exp_f32 v122, v122
    v_exp_f32 v123, v123
    v_exp_f32 v124, v124
    v_mfma_f32_32x32x16_bf16 v[104:119], v[140:143], v[64:67], 0
    v_exp_f32 v125, v125
    v_exp_f32 v126, v126
    v_exp_f32 v127, v127
    v_exp_f32 v128, v128
    v_exp_f32 v129, v129
    v_exp_f32 v130, v130
    v_smfmac_f32_32x32x32_bf16 v[88:103], v[208:211], v[120:127], v255
    v_exp_f32 v131, v131
    v_exp_f32 v132, v132
    v_exp_f32 v133, v133
    v_exp_f32 v134, v134
    v_exp_f32 v135, v135
    v_exp_f32 v104, v104
    v_exp_f32 v105, v105
    v_smfmac_f32_32x32x32_bf16 v[88:103], v[216:219], v[128:135], v255
    v_exp_f32 v106, v106
    v_exp_f32 v107, v107
    v_exp_f32 v108, v108
    v_mfma_f32_32x32x16_bf16 v[120:135], v[140:143], v[68:71], 0
    s_waitcnt lgkmcnt(0)
    v_add_u32 v231, 0xc000, v231
    v_add_u32 v232, 0xc000, v232
    ds_read_b128 v[140:143], v231 offset:2048
    s_add_u32 m0, s3, 0xa000
    s_add_u32 s12, s12, 0x10000
    buffer_load_dwordx4 v235, s[60:63], s12 offen lds
    v_exp_f32 v109, v109
    v_exp_f32 v110, v110
    v_exp_f32 v111, v111
    v_exp_f32 v112, v112
    v_exp_f32 v113, v113
    v_exp_f32 v114, v114
    v_smfmac_f32_32x32x32_bf16 v[72:87], v[212:215], v[104:111], v255
    s_mov_b64 exec, s[4:5]
    ds_read_b128 v[208:211], v232 offset:0
    ds_read_b128 v[216:219], v232 offset:512
    s_mov_b64 exec, -1
    v_exp_f32 v115, v115
    v_exp_f32 v116, v116
    v_exp_f32 v117, v117
    v_exp_f32 v118, v118
    v_exp_f32 v119, v119
    v_exp_f32 v120, v120
    v_exp_f32 v121, v121
    v_smfmac_f32_32x32x32_bf16 v[72:87], v[220:223], v[112:119], v255
    v_exp_f32 v122, v122
    v_exp_f32 v123, v123
    v_exp_f32 v124, v124
    v_mfma_f32_32x32x16_bf16 v[104:119], v[136:139], v[64:67], 0
    v_exp_f32 v125, v125
    v_exp_f32 v126, v126
    v_exp_f32 v127, v127
    v_exp_f32 v128, v128
    v_exp_f32 v129, v129
    v_exp_f32 v130, v130
    v_smfmac_f32_32x32x32_bf16 v[88:103], v[212:215], v[120:127], v255
    v_exp_f32 v131, v131
    v_exp_f32 v132, v132
    v_exp_f32 v133, v133
    v_exp_f32 v134, v134
    v_exp_f32 v135, v135
    v_exp_f32 v104, v104
    v_exp_f32 v105, v105
    v_smfmac_f32_32x32x32_bf16 v[88:103], v[220:223], v[128:135], v255
    v_exp_f32 v106, v106
    v_exp_f32 v107, v107
    v_exp_f32 v108, v108
    v_mfma_f32_32x32x16_bf16 v[120:135], v[136:139], v[68:71], 0
    s_waitcnt lgkmcnt(0)
    ds_read_b128 v[136:139], v231 offset:4096
    s_add_u32 m0, s3, 0xc000
    s_add_u32 s12, s12, 0x10000
    buffer_load_dwordx4 v235, s[60:63], s12 offen lds
    v_exp_f32 v109, v109
    v_exp_f32 v110, v110
    v_exp_f32 v111, v111
    v_exp_f32 v112, v112
    v_exp_f32 v113, v113
    v_exp_f32 v114, v114
    v_smfmac_f32_32x32x32_bf16 v[72:87], v[208:211], v[104:111], v255
    s_mov_b64 exec, s[4:5]
    ds_read_b128 v[212:215], v232 offset:2048
    ds_read_b128 v[220:223], v232 offset:2560
    s_mov_b64 exec, -1
    v_exp_f32 v115, v115
    v_exp_f32 v116, v116
    v_exp_f32 v117, v117
    v_exp_f32 v118, v118
    v_exp_f32 v119, v119
    v_exp_f32 v120, v120
    v_exp_f32 v121, v121
    v_smfmac_f32_32x32x32_bf16 v[72:87], v[216:219], v[112:119], v255
    v_exp_f32 v122, v122
    v_exp_f32 v123, v123
    v_exp_f32 v124, v124
    v_mfma_f32_32x32x16_bf16 v[104:119], v[140:143], v[64:67], 0
    v_exp_f32 v125, v125
    v_exp_f32 v126, v126
    v_exp_f32 v127, v127
    v_exp_f32 v128, v128
    v_exp_f32 v129, v129
    v_exp_f32 v130, v130
    v_smfmac_f32_32x32x32_bf16 v[88:103], v[208:211], v[120:127], v255
    v_exp_f32 v131, v131
    v_exp_f32 v132, v132
    v_exp_f32 v133, v133
    v_exp_f32 v134, v134
    v_exp_f32 v135, v135
    v_exp_f32 v104, v104
    v_exp_f32 v105, v105
    v_smfmac_f32_32x32x32_bf16 v[88:103], v[216:219], v[128:135], v255
    v_exp_f32 v106, v106
    v_exp_f32 v107, v107
    v_exp_f32 v108, v108
    v_mfma_f32_32x32x16_bf16 v[120:135], v[140:143], v[68:71], 0
    s_waitcnt lgkmcnt(0)
    ds_read_b128 v[140:143], v231 offset:6144
    buffer_store_dword v12, v234, s[56:59], s38 offen
    s_add_u32 s38, s38, 0x100000
    v_exp_f32 v109, v109
    v_exp_f32 v110, v110
    v_exp_f32 v111, v111
    v_exp_f32 v112, v112
    v_exp_f32 v113, v113
    v_exp_f32 v114, v114
    v_smfmac_f32_32x32x32_bf16 v[72:87], v[212:215], v[104:111], v255
    s_mov_b64 exec, s[4:5]
    ds_read_b128 v[208:211], v232 offset:4096
    ds_read_b128 v[216:219], v232 offset:4608
    s_mov_b64 exec, -1
    v_exp_f32 v115, v115
    v_exp_f32 v116, v116
    v_exp_f32 v117, v117
    v_exp_f32 v118, v118
    v_exp_f32 v119, v119
    v_exp_f32 v120, v120
    v_exp_f32 v121, v121
    v_smfmac_f32_32x32x32_bf16 v[72:87], v[220:223], v[112:119], v255
    v_exp_f32 v122, v122
    v_exp_f32 v123, v123
    v_exp_f32 v124, v124
    v_mfma_f32_32x32x16_bf16 v[104:119], v[136:139], v[64:67], 0
    v_exp_f32 v125, v125
    v_exp_f32 v126, v126
    v_exp_f32 v127, v127
    v_exp_f32 v128, v128
    v_exp_f32 v129, v129
    v_exp_f32 v130, v130
    v_smfmac_f32_32x32x32_bf16 v[88:103], v[212:215], v[120:127], v255
    v_exp_f32 v131, v131
    v_exp_f32 v132, v132
    v_exp_f32 v133, v133
    v_exp_f32 v134, v134
    v_exp_f32 v135, v135
    v_exp_f32 v104, v104
    v_exp_f32 v105, v105
    v_smfmac_f32_32x32x32_bf16 v[88:103], v[220:223], v[128:135], v255
    v_exp_f32 v106, v106
    v_exp_f32 v107, v107
    v_exp_f32 v108, v108
    v_mfma_f32_32x32x16_bf16 v[120:135], v[136:139], v[68:71], 0
    s_waitcnt lgkmcnt(0)
    ds_read_b128 v[136:139], v231 offset:16384
    s_add_u32 m0, s3, 0xe000
    s_add_u32 s12, s12, 0x10000
    buffer_load_dwordx4 v235, s[60:63], s12 offen lds
    v_exp_f32 v109, v109
    v_exp_f32 v110, v110
    v_exp_f32 v111, v111
    v_exp_f32 v112, v112
    v_exp_f32 v113, v113
    v_exp_f32 v114, v114
    v_smfmac_f32_32x32x32_bf16 v[72:87], v[208:211], v[104:111], v255
    s_mov_b64 exec, s[4:5]
    ds_read_b128 v[212:215], v232 offset:6144
    ds_read_b128 v[220:223], v232 offset:6656
    s_mov_b64 exec, -1
    v_exp_f32 v115, v115
    v_exp_f32 v116, v116
    v_exp_f32 v117, v117
    v_exp_f32 v118, v118
    v_exp_f32 v119, v119
    v_exp_f32 v120, v120
    v_exp_f32 v121, v121
    v_smfmac_f32_32x32x32_bf16 v[72:87], v[216:219], v[112:119], v255
    v_exp_f32 v122, v122
    v_exp_f32 v123, v123
    v_exp_f32 v124, v124
    v_mfma_f32_32x32x16_bf16 v[104:119], v[140:143], v[64:67], 0
    v_exp_f32 v125, v125
    v_exp_f32 v126, v126
    v_exp_f32 v127, v127
    v_exp_f32 v128, v128
    v_exp_f32 v129, v129
    v_exp_f32 v130, v130
    v_smfmac_f32_32x32x32_bf16 v[88:103], v[208:211], v[120:127], v255
    v_exp_f32 v131, v131
    v_exp_f32 v132, v132
    v_exp_f32 v133, v133
    v_exp_f32 v134, v134
    v_exp_f32 v135, v135
    v_exp_f32 v104, v104
    v_exp_f32 v105, v105
    v_smfmac_f32_32x32x32_bf16 v[88:103], v[216:219], v[128:135], v255
    v_exp_f32 v106, v106
    v_exp_f32 v107, v107
    v_exp_f32 v108, v108
    v_mfma_f32_32x32x16_bf16 v[120:135], v[140:143], v[68:71], 0
    s_waitcnt lgkmcnt(0)
    ds_read_b128 v[140:143], v231 offset:18432
    v_exp_f32 v109, v109
    v_exp_f32 v110, v110
    v_exp_f32 v111, v111
    v_exp_f32 v112, v112
    v_exp_f32 v113, v113
    v_exp_f32 v114, v114
    v_smfmac_f32_32x32x32_bf16 v[72:87], v[212:215], v[104:111], v255
    s_mov_b64 exec, s[4:5]
    ds_read_b128 v[208:211], v232 offset:16384
    ds_read_b128 v[216:219], v232 offset:16896
    s_mov_b64 exec, -1
    v_exp_f32 v115, v115
    v_exp_f32 v116, v116
    v_exp_f32 v117, v117
    v_exp_f32 v118, v118
    v_exp_f32 v119, v119
    v_exp_f32 v120, v120
    v_exp_f32 v121, v121
    v_smfmac_f32_32x32x32_bf16 v[72:87], v[220:223], v[112:119], v255
    v_exp_f32 v122, v122
    v_exp_f32 v123, v123
    v_exp_f32 v124, v124
    v_mfma_f32_32x32x16_bf16 v[104:119], v[136:139], v[64:67], 0
    v_exp_f32 v125, v125
    v_exp_f32 v126, v126
    v_exp_f32 v127, v127
    v_exp_f32 v128, v128
    v_exp_f32 v129, v129
    v_exp_f32 v130, v130
    v_smfmac_f32_32x32x32_bf16 v[88:103], v[212:215], v[120:127], v255
    v_exp_f32 v131, v131
    v_exp_f32 v132, v132
    v_exp_f32 v133, v133
    v_exp_f32 v134, v134
    v_exp_f32 v135, v135
    v_exp_f32 v104, v104
    v_exp_f32 v105, v105
    v_smfmac_f32_32x32x32_bf16 v[88:103], v[220:223], v[128:135], v255
    v_exp_f32 v106, v106
    v_exp_f32 v107, v107
    v_exp_f32 v108, v108
    v_mfma_f32_32x32x16_bf16 v[120:135], v[136:139], v[68:71], 0
    s_waitcnt lgkmcnt(0)
    ds_read_b128 v[136:139], v231 offset:20480
    v_exp_f32 v109, v109
    v_exp_f32 v110, v110
    v_exp_f32 v111, v111
    v_exp_f32 v112, v112
    v_exp_f32 v113, v113
    v_exp_f32 v114, v114
    v_smfmac_f32_32x32x32_bf16 v[72:87], v[208:211], v[104:111], v255
    s_mov_b64 exec, s[4:5]
    ds_read_b128 v[212:215], v232 offset:18432
    ds_read_b128 v[220:223], v232 offset:18944
    s_mov_b64 exec, -1
    v_exp_f32 v115, v115
    v_exp_f32 v116, v116
    v_exp_f32 v117, v117
    v_exp_f32 v118, v118
    v_exp_f32 v119, v119
    v_exp_f32 v120, v120
    v_exp_f32 v121, v121
    v_smfmac_f32_32x32x32_bf16 v[72:87], v[216:219], v[112:119], v255
    v_exp_f32 v122, v122
    v_exp_f32 v123, v123
    v_exp_f32 v124, v124
    v_mfma_f32_32x32x16_bf16 v[104:119], v[140:143], v[64:67], 0
    v_exp_f32 v125, v125
    v_exp_f32 v126, v126
    v_exp_f32 v127, v127
    v_exp_f32 v128, v128
    v_exp_f32 v129, v129
    v_exp_f32 v130, v130
    v_smfmac_f32_32x32x32_bf16 v[88:103], v[208:211], v[120:127], v255
    v_exp_f32 v131, v131
    v_exp_f32 v132, v132
    v_exp_f32 v133, v133
    v_exp_f32 v134, v134
    v_exp_f32 v135, v135
    s_cmp_ge_u32 s66, 4
    s_cbranch_scc1 L_noflip29
    s_setprio 0
L_noflip29:
    v_exp_f32 v104, v104
    v_exp_f32 v105, v105
    v_smfmac_f32_32x32x32_bf16 v[88:103], v[216:219], v[128:135], v255
    v_exp_f32 v106, v106
    v_exp_f32 v107, v107
    v_exp_f32 v108, v108
    v_mfma_f32_32x32x16_bf16 v[120:135], v[140:143], v[68:71], 0
    s_waitcnt lgkmcnt(0)
    ds_read_b128 v[140:143], v231 offset:22528
    v_exp_f32 v109, v109
    v_exp_f32 v110, v110
    v_exp_f32 v111, v111
    v_exp_f32 v112, v112
    v_exp_f32 v113, v113
    v_exp_f32 v114, v114
    v_smfmac_f32_32x32x32_bf16 v[72:87], v[212:215], v[104:111], v255
    s_mov_b64 exec, s[4:5]
    ds_read_b128 v[208:211], v232 offset:20480
    ds_read_b128 v[216:219], v232 offset:20992
    s_mov_b64 exec, -1
    v_exp_f32 v115, v115
    v_exp_f32 v116, v116
    v_exp_f32 v117, v117
    v_exp_f32 v118, v118
    v_exp_f32 v119, v119
    v_exp_f32 v120, v120
    v_exp_f32 v121, v121
    v_smfmac_f32_32x32x32_bf16 v[72:87], v[220:223], v[112:119], v255
    v_exp_f32 v122, v122
    v_exp_f32 v123, v123
    v_exp_f32 v124, v124
    v_mfma_f32_32x32x16_bf16 v[104:119], v[136:139], v[64:67], 0
    v_exp_f32 v125, v125
    v_exp_f32 v126, v126
    v_exp_f32 v127, v127
    v_exp_f32 v128, v128
    v_exp_f32 v129, v129
    v_exp_f32 v130, v130
    v_smfmac_f32_32x32x32_bf16 v[88:103], v[212:215], v[120:127], v255
    v_exp_f32 v131, v131
    v_exp_f32 v132, v132
    v_exp_f32 v133, v133
    v_exp_f32 v134, v134
    v_exp_f32 v135, v135
    v_exp_f32 v104, v104
    v_exp_f32 v105, v105
    v_smfmac_f32_32x32x32_bf16 v[88:103], v[220:223], v[128:135], v255
    v_exp_f32 v106, v106
    v_exp_f32 v107, v107
    v_exp_f32 v108, v108
    v_mfma_f32_32x32x16_bf16 v[120:135], v[136:139], v[68:71], 0
    s_waitcnt lgkmcnt(0)
    v_exp_f32 v109, v109
    v_exp_f32 v110, v110
    v_exp_f32 v111, v111
    v_exp_f32 v112, v112
    v_exp_f32 v113, v113
    v_exp_f32 v114, v114
    v_smfmac_f32_32x32x32_bf16 v[72:87], v[208:211], v[104:111], v255
    s_mov_b64 exec, s[4:5]
    ds_read_b128 v[212:215], v232 offset:22528
    ds_read_b128 v[220:223], v232 offset:23040
    s_mov_b64 exec, -1
    v_exp_f32 v115, v115
    v_exp_f32 v116, v116
    v_exp_f32 v117, v117
    v_exp_f32 v118, v118
    v_exp_f32 v119, v119
    v_exp_f32 v120, v120
    v_exp_f32 v121, v121
    v_smfmac_f32_32x32x32_bf16 v[72:87], v[216:219], v[112:119], v255
    v_exp_f32 v122, v122
    v_exp_f32 v123, v123
    v_exp_f32 v124, v124
    v_mfma_f32_32x32x16_bf16 v[104:119], v[140:143], v[64:67], 0
    v_exp_f32 v125, v125
    v_exp_f32 v126, v126
    v_exp_f32 v127, v127
    v_exp_f32 v128, v128
    v_exp_f32 v129, v129
    v_exp_f32 v130, v130
    v_smfmac_f32_32x32x32_bf16 v[88:103], v[208:211], v[120:127], v255
    v_exp_f32 v131, v131
    v_exp_f32 v132, v132
    v_exp_f32 v133, v133
    v_exp_f32 v134, v134
    v_exp_f32 v135, v135
    v_exp_f32 v104, v104
    v_exp_f32 v105, v105
    v_smfmac_f32_32x32x32_bf16 v[88:103], v[216:219], v[128:135], v255
    v_exp_f32 v106, v106
    v_exp_f32 v107, v107
    v_exp_f32 v108, v108
    v_mfma_f32_32x32x16_bf16 v[120:135], v[140:143], v[68:71], 0
    s_waitcnt lgkmcnt(0)
    v_exp_f32 v109, v109
    v_exp_f32 v110, v110
    v_exp_f32 v111, v111
    v_exp_f32 v112, v112
    v_exp_f32 v113, v113
    v_exp_f32 v114, v114
    v_smfmac_f32_32x32x32_bf16 v[72:87], v[212:215], v[104:111], v255
    v_exp_f32 v115, v115
    v_exp_f32 v116, v116
    v_exp_f32 v117, v117
    v_exp_f32 v118, v118
    v_exp_f32 v119, v119
    v_exp_f32 v120, v120
    v_exp_f32 v121, v121
    v_smfmac_f32_32x32x32_bf16 v[72:87], v[220:223], v[112:119], v255
    v_exp_f32 v122, v122
    v_exp_f32 v123, v123
    v_exp_f32 v124, v124
    v_exp_f32 v125, v125
    v_exp_f32 v126, v126
    v_exp_f32 v127, v127
    v_exp_f32 v128, v128
    v_exp_f32 v129, v129
    v_exp_f32 v130, v130
    v_smfmac_f32_32x32x32_bf16 v[88:103], v[212:215], v[120:127], v255
    v_exp_f32 v131, v131
    v_exp_f32 v132, v132
    v_exp_f32 v133, v133
    v_exp_f32 v134, v134
    v_exp_f32 v135, v135
    s_nop 1
    v_smfmac_f32_32x32x32_bf16 v[88:103], v[220:223], v[128:135], v255
    s_setprio 0
    s_waitcnt vmcnt(0)
    s_barrier
    s_cmp_ge_u32 s66, 4
    s_cbranch_scc0 L_cmb0
    ds_write_b128 v236, v[72:75] offset:0
    ds_write_b128 v236, v[76:79] offset:1024
    ds_write_b128 v236, v[80:83] offset:2048
    s_nop 4
    ds_write_b128 v236, v[88:91] offset:3072
    ds_write_b128 v236, v[92:95] offset:4096
    ds_write_b128 v236, v[96:99] offset:5120
    s_waitcnt lgkmcnt(0)
    s_barrier
    s_branch L_tail_hi
L_cmb0:
    s_barrier
    ds_read_b128 v[172:175], v236 offset:2048
    ds_read_b128 v[164:167], v236 offset:0
    ds_read_b128 v[168:171], v236 offset:1024
    ds_read_b128 v[184:187], v236 offset:5120
    ds_read_b128 v[176:179], v236 offset:3072
    ds_read_b128 v[180:183], v236 offset:4096
    s_waitcnt lgkmcnt(5)
    v_add_f32 v172, v172, v80
    v_mov_b32 v15, v172
    s_waitcnt lgkmcnt(3)
    v_add_f32 v164, v164, v72
    v_add_f32 v165, v165, v73
    v_add_f32 v166, v166, v74
    v_add_f32 v167, v167, v75
    v_add_f32 v168, v168, v76
    v_add_f32 v169, v169, v77
    v_add_f32 v170, v170, v78
    v_add_f32 v171, v171, v79
    v_permlane32_swap_b32 v172, v15
    v_rcp_f32 v14, v172
    s_nop 0
    v_mul_f32 v164, v164, v14
    v_mul_f32 v165, v165, v14
    v_mul_f32 v166, v166, v14
    v_mul_f32 v167, v167, v14
    v_mul_f32 v168, v168, v14
    v_mul_f32 v169, v169, v14
    v_mul_f32 v170, v170, v14
    v_mul_f32 v171, v171, v14
    v_cvt_pk_bf16_f32 v32, v164, v165
    v_cvt_pk_bf16_f32 v33, v166, v167
    v_cvt_pk_bf16_f32 v34, v168, v169
    v_cvt_pk_bf16_f32 v35, v170, v171
    s_nop 1
    v_permlane32_swap_b32 v32, v34
    v_permlane32_swap_b32 v33, v35
    buffer_store_dwordx4 v[32:35], v2, s[48:51], s13 offen offset:0 sc1
    s_waitcnt lgkmcnt(2)
    v_add_f32 v184, v184, v96
    v_mov_b32 v15, v184
    s_waitcnt lgkmcnt(0)
    v_add_f32 v176, v176, v88
    v_add_f32 v177, v177, v89
    v_add_f32 v178, v178, v90
    v_add_f32 v179, v179, v91
    v_add_f32 v180, v180, v92
    v_add_f32 v181, v181, v93
    v_add_f32 v182, v182, v94
    v_add_f32 v183, v183, v95
    v_permlane32_swap_b32 v184, v15
    v_rcp_f32 v14, v184
    s_nop 0
    v_mul_f32 v176, v176, v14
    v_mul_f32 v177, v177, v14
    v_mul_f32 v178, v178, v14
    v_mul_f32 v179, v179, v14
    v_mul_f32 v180, v180, v14
    v_mul_f32 v181, v181, v14
    v_mul_f32 v182, v182, v14
    v_mul_f32 v183, v183, v14
    v_cvt_pk_bf16_f32 v36, v176, v177
    v_cvt_pk_bf16_f32 v37, v178, v179
    v_cvt_pk_bf16_f32 v38, v180, v181
    v_cvt_pk_bf16_f32 v39, v182, v183
    s_nop 1
    v_permlane32_swap_b32 v36, v38
    v_permlane32_swap_b32 v37, v39
    buffer_store_dwordx4 v[36:39], v2, s[48:51], s13 offen offset:1024 sc1
    v_mov_b32 v15, 0x71800000
    v_mul_f32 v14, 0, v164
    v_fma_f32 v14, v165, 0, v14
    v_fma_f32 v14, v166, 0, v14
    v_fma_f32 v14, v167, 0, v14
    v_fma_f32 v14, v168, 0, v14
    v_fma_f32 v14, v169, 0, v14
    v_fma_f32 v14, v170, 0, v14
    v_fma_f32 v14, v171, 0, v14
    v_cmp_nle_f32 vcc, 0x2b800000, v172
    v_cmp_nle_f32 s[4:5], v172, v15
    v_cmp_neq_f32 s[6:7], 0, v14
    s_or_b64 vcc, vcc, s[4:5]
    s_or_b64 vcc, vcc, s[6:7]
    s_cmp_lg_u64 vcc, 0
    s_cselect_b32 s77, 1, 0
    v_mul_f32 v14, 0, v176
    v_fma_f32 v14, v177, 0, v14
    v_fma_f32 v14, v178, 0, v14
    v_fma_f32 v14, v179, 0, v14
    v_fma_f32 v14, v180, 0, v14
    v_fma_f32 v14, v181, 0, v14
    v_fma_f32 v14, v182, 0, v14
    v_fma_f32 v14, v183, 0, v14
    v_cmp_nle_f32 vcc, 0x2b800000, v184
    v_cmp_nle_f32 s[4:5], v184, v15
    v_cmp_neq_f32 s[6:7], 0, v14
    s_or_b64 vcc, vcc, s[4:5]
    s_or_b64 vcc, vcc, s[6:7]
    s_cmp_lg_u64 vcc, 0
    s_cselect_b32 s78, 1, 0
    s_or_b32 s73, s77, s78
    s_cbranch_scc1 L_slow
L_attn_ok:
    ds_read_b64_tr_b16 v[96:97], v240 offset:0
    ds_read_b64_tr_b16 v[98:99], v240 offset:512
    ds_read_b64_tr_b16 v[100:101], v240 offset:2048
    ds_read_b64_tr_b16 v[102:103], v240 offset:2560
    ds_read_b64_tr_b16 v[104:105], v240 offset:4096
    ds_read_b64_tr_b16 v[106:107], v240 offset:4608
    ds_read_b64_tr_b16 v[108:109], v240 offset:6144
    ds_read_b64_tr_b16 v[110:111], v240 offset:6656
    ds_read_b64_tr_b16 v[112:113], v240 offset:8192
    ds_read_b64_tr_b16 v[114:115], v240 offset:8704
    ds_read_b64_tr_b16 v[116:117], v240 offset:10240
    ds_read_b64_tr_b16 v[118:119], v240 offset:10752
    ds_read_b64_tr_b16 v[120:121], v240 offset:12288
    ds_read_b64_tr_b16 v[122:123], v240 offset:12800
    ds_read_b64_tr_b16 v[124:125], v240 offset:14336
    ds_read_b64_tr_b16 v[126:127], v240 offset:14848
    ds_read_b64_tr_b16 v[128:129], v240 offset:16384
    ds_read_b64_tr_b16 v[130:131], v240 offset:16896
    ds_read_b64_tr_b16 v[132:133], v240 offset:18432
    ds_read_b64_tr_b16 v[134:135], v240 offset:18944
    ds_read_b64_tr_b16 v[136:137], v240 offset:20480
    ds_read_b64_tr_b16 v[138:139], v240 offset:20992
    ds_read_b64_tr_b16 v[140:141], v240 offset:22528
    ds_read_b64_tr_b16 v[142:143], v240 offset:23040
    ds_read_b64_tr_b16 v[144:145], v240 offset:24576
    ds_read_b64_tr_b16 v[146:147], v240 offset:25088
    ds_read_b64_tr_b16 v[148:149], v240 offset:26624
    ds_read_b64_tr_b16 v[150:151], v240 offset:27136
    ds_read_b64_tr_b16 v[152:153], v240 offset:28672
    ds_read_b64_tr_b16 v[154:155], v240 offset:29184
    ds_read_b64_tr_b16 v[156:157], v240 offset:30720
    ds_read_b64_tr_b16 v[158:159], v240 offset:31232
    v_mov_b32 v20, 0x23b54
    v_mov_b32 v21, 1
    s_waitcnt vmcnt(0)
    s_mov_b64 exec, 1
    ds_add_rtn_u32 v21, v20, v21
    s_mov_b64 exec, -1
    s_waitcnt lgkmcnt(0)
    v_readfirstlane_b32 s73, v21
    s_cmp_eq_u32 s73, 3
    s_cbranch_scc0 L_sig_c
    v_mov_b32 v18, 0
    v_mov_b32 v19, s67
    s_mov_b64 exec, 1
    buffer_store_dword v19, v18, s[48:51], s16 offen sc1
    s_mov_b64 exec, -1
L_sig_c:
    ds_read_b64_tr_b16 v[160:161], v240 offset:32768
    ds_read_b64_tr_b16 v[162:163], v240 offset:33280
    ds_read_b64_tr_b16 v[164:165], v240 offset:34816
    ds_read_b64_tr_b16 v[166:167], v240 offset:35328
    ds_read_b64_tr_b16 v[168:169], v240 offset:36864
    ds_read_b64_tr_b16 v[170:171], v240 offset:37376
    ds_read_b64_tr_b16 v[172:173], v240 offset:38912
    ds_read_b64_tr_b16 v[174:175], v240 offset:39424
    ds_read_b64_tr_b16 v[176:177], v240 offset:40960
    ds_read_b64_tr_b16 v[178:179], v240 offset:41472
    ds_read_b64_tr_b16 v[180:181], v240 offset:43008
    ds_read_b64_tr_b16 v[182:183], v240 offset:43520
    ds_read_b64_tr_b16 v[184:185], v240 offset:45056
    ds_read_b64_tr_b16 v[186:187], v240 offset:45568
    ds_read_b64_tr_b16 v[188:189], v240 offset:47104
    ds_read_b64_tr_b16 v[190:191], v240 offset:47616
    ds_read_b64_tr_b16 v[192:193], v240 offset:49152
    ds_read_b64_tr_b16 v[194:195], v240 offset:49664
    ds_read_b64_tr_b16 v[196:197], v240 offset:51200
    ds_read_b64_tr_b16 v[198:199], v240 offset:51712
    ds_read_b64_tr_b16 v[200:201], v240 offset:53248
    ds_read_b64_tr_b16 v[202:203], v240 offset:53760
    ds_read_b64_tr_b16 v[204:205], v240 offset:55296
    ds_read_b64_tr_b16 v[206:207], v240 offset:55808
    ds_read_b64_tr_b16 v[208:209], v240 offset:57344
    ds_read_b64_tr_b16 v[210:211], v240 offset:57856
    ds_read_b64_tr_b16 v[212:213], v240 offset:59392
    ds_read_b64_tr_b16 v[214:215], v240 offset:59904
    ds_read_b64_tr_b16 v[216:217], v240 offset:61440
    ds_read_b64_tr_b16 v[218:219], v240 offset:61952
    ds_read_b64_tr_b16 v[220:221], v240 offset:63488
    ds_read_b64_tr_b16 v[222:223], v240 offset:64000
    s_waitcnt lgkmcnt(0)
    s_barrier
    v_mov_b32 v16, 0x23b58
    v_mov_b32 v17, 1
    s_cmp_eq_u32 s66, 0
    s_cbranch_scc0 L_spin2
    v_lshlrev_b32 v14, 7, v1
    s_mov_b32 s79, 0
    s_mov_b32 exec_hi, 0
L_poll2:
L_poll2_go:
    buffer_load_dword v15, v14, s[48:51], s17 offen sc1
    s_add_u32 s79, s79, 1
    s_waitcnt vmcnt(0)
L_poll2_chk:
    v_cmp_ne_u32 vcc, s67, v15
    s_cmp_gt_u32 s79, 0x4000
    s_cbranch_scc1 L_poll2_done
    s_cmp_lg_u64 vcc, 0
    s_cbranch_scc1 L_poll2
L_poll2_done:
    s_mov_b32 exec_hi, -1
    ds_write_b32 v16, v17
    s_branch L_seen2
L_spin2:
    s_mov_b32 s79, 0
L_spin2l:
    ds_read_b32 v17, v16
    s_add_u32 s79, s79, 1
    s_waitcnt lgkmcnt(0)
    v_readfirstlane_b32 s73, v17
    s_cmp_gt_u32 s79, 0x200000
    s_cbranch_scc1 L_seen2
    s_cmp_eq_u32 s73, 0
    s_cbranch_scc1 L_spin2l
L_seen2:
    s_add_u32 m0, s3, 0x10000
    s_nop 0
    buffer_load_dwordx4 v2, s[48:51], s14 offen sc1 lds
    s_add_u32 m0, m0, 0x1000
    s_add_u32 s14, s14, 0x20000
    buffer_load_dwordx4 v2, s[48:51], s14 offen sc1 lds
    s_add_u32 m0, m0, 0x1000
    s_add_u32 s14, s14, 0x20000
    buffer_load_dwordx4 v2, s[48:51], s14 offen sc1 lds
    s_add_u32 m0, m0, 0x1000
    s_add_u32 s14, s14, 0x20000
    buffer_load_dwordx4 v2, s[48:51], s14 offen sc1 lds
    s_add_u32 m0, m0, 0x1000
    s_add_u32 s14, s14, 0x20000
    buffer_load_dwordx4 v2, s[48:51], s14 offen sc1 lds
    s_add_u32 m0, m0, 0x1000
    s_add_u32 s14, s14, 0x20000
    buffer_load_dwordx4 v2, s[48:51], s14 offen sc1 lds
    s_add_u32 m0, m0, 0x1000
    s_add_u32 s14, s14, 0x20000
    buffer_load_dwordx4 v2, s[48:51], s14 offen sc1 lds
    s_add_u32 m0, m0, 0x1000
    s_add_u32 s14, s14, 0x20000
    buffer_load_dwordx4 v2, s[48:51], s14 offen sc1 lds
    s_add_u32 m0, m0, 0x1000
    s_add_u32 s14, s14, 0x20000
    buffer_load_dwordx4 v2, s[48:51], s14 offen sc1 lds
    s_add_u32 m0, m0, 0x1000
    s_add_u32 s14, s14, 0x20000
    buffer_load_dwordx4 v2, s[48:51], s14 offen sc1 lds
    s_add_u32 m0, m0, 0x1000
    s_add_u32 s14, s14, 0x20000
    buffer_load_dwordx4 v2, s[48:51], s14 offen sc1 lds
    s_add_u32 m0, m0, 0x1000
    s_add_u32 s14, s14, 0x20000
    buffer_load_dwordx4 v2, s[48:51], s14 offen sc1 lds
    s_add_u32 m0, m0, 0x1000
    s_add_u32 s14, s14, 0x20000
    buffer_load_dwordx4 v2, s[48:51], s14 offen sc1 lds
    s_add_u32 m0, m0, 0x1000
    s_add_u32 s14, s14, 0x20000
    buffer_load_dwordx4 v2, s[48:51], s14 offen sc1 lds
    s_add_u32 m0, m0, 0x1000
    s_add_u32 s14, s14, 0x20000
    buffer_load_dwordx4 v2, s[48:51], s14 offen sc1 lds
    s_add_u32 m0, m0, 0x1000
    s_add_u32 s14, s14, 0x20000
    buffer_load_dwordx4 v2, s[48:51], s14 offen sc1 lds
    s_barrier
    s_waitcnt vmcnt(14)
    s_barrier
    ds_read_b128 v[48:51], v238 offset:0
    ds_read_b128 v[52:55], v238 offset:2048
    ds_read_b128 v[56:59], v238 offset:4096
    ds_read_b128 v[60:63], v238 offset:6144
    s_waitcnt vmcnt(10)
    s_barrier
    ds_read_b128 v[64:67], v238 offset:8192
    ds_read_b128 v[68:71], v238 offset:10240
    ds_read_b128 v[72:75], v238 offset:12288
    ds_read_b128 v[76:79], v238 offset:14336
    s_waitcnt lgkmcnt(4)
    v_mfma_f32_32x32x16_bf16 v[32:47], v[96:99], v[48:51], 0
    v_mfma_f32_32x32x16_bf16 v[32:47], v[100:103], v[52:55], v[32:47]
    v_mfma_f32_32x32x16_bf16 v[32:47], v[104:107], v[56:59], v[32:47]
    v_mfma_f32_32x32x16_bf16 v[32:47], v[108:111], v[60:63], v[32:47]
    ds_read_b128 v[48:51], v238 offset:16384
    ds_read_b128 v[52:55], v238 offset:18432
    ds_read_b128 v[56:59], v238 offset:20480
    ds_read_b128 v[60:63], v238 offset:22528
    s_waitcnt lgkmcnt(4)
    v_mfma_f32_32x32x16_bf16 v[32:47], v[112:115], v[64:67], v[32:47]
    v_mfma_f32_32x32x16_bf16 v[32:47], v[116:119], v[68:71], v[32:47]
    v_mfma_f32_32x32x16_bf16 v[32:47], v[120:123], v[72:75], v[32:47]
    v_mfma_f32_32x32x16_bf16 v[32:47], v[124:127], v[76:79], v[32:47]
    s_waitcnt vmcnt(6)
    s_barrier
    ds_read_b128 v[64:67], v238 offset:24576
    ds_read_b128 v[68:71], v238 offset:26624
    ds_read_b128 v[72:75], v238 offset:28672
    ds_read_b128 v[76:79], v238 offset:30720
    s_waitcnt lgkmcnt(4)
    v_mfma_f32_32x32x16_bf16 v[32:47], v[128:131], v[48:51], v[32:47]
    v_mfma_f32_32x32x16_bf16 v[32:47], v[132:135], v[52:55], v[32:47]
    v_mfma_f32_32x32x16_bf16 v[32:47], v[136:139], v[56:59], v[32:47]
    v_mfma_f32_32x32x16_bf16 v[32:47], v[140:143], v[60:63], v[32:47]
    ds_read_b128 v[48:51], v238 offset:32768
    ds_read_b128 v[52:55], v238 offset:34816
    ds_read_b128 v[56:59], v238 offset:36864
    ds_read_b128 v[60:63], v238 offset:38912
    s_waitcnt lgkmcnt(4)
    v_mfma_f32_32x32x16_bf16 v[32:47], v[144:147], v[64:67], v[32:47]
    v_mfma_f32_32x32x16_bf16 v[32:47], v[148:151], v[68:71], v[32:47]
    v_mfma_f32_32x32x16_bf16 v[32:47], v[152:155], v[72:75], v[32:47]
    v_mfma_f32_32x32x16_bf16 v[32:47], v[156:159], v[76:79], v[32:47]
    s_waitcnt vmcnt(0)
    s_barrier
    ds_read_b128 v[64:67], v238 offset:40960
    ds_read_b128 v[68:71], v238 offset:43008
    ds_read_b128 v[72:75], v238 offset:45056
    ds_read_b128 v[76:79], v238 offset:47104
    s_waitcnt lgkmcnt(4)
    v_mfma_f32_32x32x16_bf16 v[32:47], v[160:163], v[48:51], v[32:47]
    v_mfma_f32_32x32x16_bf16 v[32:47], v[164:167], v[52:55], v[32:47]
    v_mfma_f32_32x32x16_bf16 v[32:47], v[168:171], v[56:59], v[32:47]
    v_mfma_f32_32x32x16_bf16 v[32:47], v[172:175], v[60:63], v[32:47]
    ds_read_b128 v[48:51], v238 offset:49152
    ds_read_b128 v[52:55], v238 offset:51200
    ds_read_b128 v[56:59], v238 offset:53248
    ds_read_b128 v[60:63], v238 offset:55296
    s_waitcnt lgkmcnt(4)
    v_mfma_f32_32x32x16_bf16 v[32:47], v[176:179], v[64:67], v[32:47]
    v_mfma_f32_32x32x16_bf16 v[32:47], v[180:183], v[68:71], v[32:47]
    v_mfma_f32_32x32x16_bf16 v[32:47], v[184:187], v[72:75], v[32:47]
    v_mfma_f32_32x32x16_bf16 v[32:47], v[188:191], v[76:79], v[32:47]
    ds_read_b128 v[64:67], v238 offset:57344
    ds_read_b128 v[68:71], v238 offset:59392
    ds_read_b128 v[72:75], v238 offset:61440
    ds_read_b128 v[76:79], v238 offset:63488
    s_waitcnt lgkmcnt(4)
    v_mfma_f32_32x32x16_bf16 v[32:47], v[192:195], v[48:51], v[32:47]
    v_mfma_f32_32x32x16_bf16 v[32:47], v[196:199], v[52:55], v[32:47]
    v_mfma_f32_32x32x16_bf16 v[32:47], v[200:203], v[56:59], v[32:47]
    v_mfma_f32_32x32x16_bf16 v[32:47], v[204:207], v[60:63], v[32:47]
    s_waitcnt lgkmcnt(0)
    v_mfma_f32_32x32x16_bf16 v[32:47], v[208:211], v[64:67], v[32:47]
    v_mfma_f32_32x32x16_bf16 v[32:47], v[212:215], v[68:71], v[32:47]
    v_mfma_f32_32x32x16_bf16 v[32:47], v[216:219], v[72:75], v[32:47]
    v_mfma_f32_32x32x16_bf16 v[32:47], v[220:223], v[76:79], v[32:47]
    s_nop 11
    v_cvt_pk_bf16_f32 v48, v32, v33
    v_cvt_pk_bf16_f32 v49, v34, v35
    v_cvt_pk_bf16_f32 v50, v36, v37
    v_cvt_pk_bf16_f32 v51, v38, v39
    v_cvt_pk_bf16_f32 v52, v40, v41
    v_cvt_pk_bf16_f32 v53, v42, v43
    v_cvt_pk_bf16_f32 v54, v44, v45
    v_cvt_pk_bf16_f32 v55, v46, v47
    ds_write_b128 v239, v[48:51]
    ds_write_b128 v239, v[52:55] offset:16
    s_cmp_eq_u32 s2, 0
    s_cbranch_scc0 L_fin
    s_cmp_eq_u32 s66, 0
    s_cbranch_scc0 L_fin
    v_mov_b32 v14, 0
    v_mov_b32 v15, s67
    s_mov_b64 exec, 1
    buffer_store_dword v15, v14, s[48:51], 0 offen sc1
    s_mov_b64 exec, -1
    s_branch L_fin
L_tail_hi:
    v_add_u32 v227, 0xfffed740, v227
    v_add_u32 v228, 0xfffebbb0, v228
    v_add_u32 v229, 0xfffea020, v229
    v_add_u32 v230, 0xfffe8490, v230
    s_bitcmp1_b32 s66, 0
    s_cbranch_scc1 L_ct_b
    ds_read_b64_tr_b16 v[160:161], v224 offset:32
    ds_read_b64_tr_b16 v[162:163], v224 offset:0
    ds_read_b128 v[192:195], v225 offset:1008
    ds_read_b128 v[176:179], v225 offset:880
    ds_read_b64_tr_b16 v[164:165], v224 offset:160
    ds_read_b64_tr_b16 v[166:167], v224 offset:128
    ds_read_b128 v[196:199], v225 offset:976
    ds_read_b128 v[180:183], v225 offset:848
    ds_read_b64_tr_b16 v[168:169], v224 offset:288
    ds_read_b64_tr_b16 v[170:171], v224 offset:256
    ds_read_b128 v[200:203], v225 offset:944
    ds_read_b128 v[184:187], v225 offset:816
    ds_read_b64_tr_b16 v[172:173], v224 offset:416
    ds_read_b64_tr_b16 v[174:175], v224 offset:384
    ds_read_b128 v[204:207], v225 offset:912
    ds_read_b128 v[188:191], v225 offset:784
    s_waitcnt lgkmcnt(12)
    v_mfma_f32_32x32x16_bf16 v[144:159], v[160:163], v[192:195], 0
    ds_read_b128 v[192:195], v225 offset:752
    v_mfma_f32_32x32x16_bf16 v[128:143], v[160:163], v[176:179], 0
    ds_read_b64_tr_b16 v[160:161], v224 offset:544
    ds_read_b64_tr_b16 v[162:163], v224 offset:512
    s_waitcnt lgkmcnt(11)
    v_mfma_f32_32x32x16_bf16 v[144:159], v[164:167], v[196:199], v[144:159]
    ds_read_b128 v[196:199], v225 offset:720
    v_mfma_f32_32x32x16_bf16 v[128:143], v[164:167], v[180:183], v[128:143]
    ds_read_b64_tr_b16 v[164:165], v224 offset:672
    ds_read_b64_tr_b16 v[166:167], v224 offset:640
    s_waitcnt lgkmcnt(10)
    v_mfma_f32_32x32x16_bf16 v[144:159], v[168:171], v[200:203], v[144:159]
    ds_read_b128 v[200:203], v225 offset:688
    v_mfma_f32_32x32x16_bf16 v[128:143], v[168:171], v[184:187], v[128:143]
    ds_read_b64_tr_b16 v[168:169], v224 offset:800
    ds_read_b64_tr_b16 v[170:171], v224 offset:768
    s_waitcnt lgkmcnt(9)
    v_mfma_f32_32x32x16_bf16 v[144:159], v[172:175], v[204:207], v[144:159]
    ds_read_b128 v[204:207], v225 offset:656
    v_mfma_f32_32x32x16_bf16 v[128:143], v[172:175], v[188:191], v[128:143]
    ds_read_b64_tr_b16 v[172:173], v224 offset:928
    ds_read_b64_tr_b16 v[174:175], v224 offset:896
    s_waitcnt lgkmcnt(9)
    v_mfma_f32_32x32x16_bf16 v[144:159], v[160:163], v[176:179], v[144:159]
    ds_read_b128 v[176:179], v225 offset:624
    v_mfma_f32_32x32x16_bf16 v[128:143], v[160:163], v[192:195], v[128:143]
    ds_read_b64_tr_b16 v[160:161], v224 offset:1056
    ds_read_b64_tr_b16 v[162:163], v224 offset:1024
    s_waitcnt lgkmcnt(9)
    v_mfma_f32_32x32x16_bf16 v[144:159], v[164:167], v[180:183], v[144:159]
    ds_read_b128 v[180:183], v225 offset:592
    v_mfma_f32_32x32x16_bf16 v[128:143], v[164:167], v[196:199], v[128:143]
    ds_read_b64_tr_b16 v[164:165], v224 offset:1184
    ds_read_b64_tr_b16 v[166:167], v224 offset:1152
    s_waitcnt lgkmcnt(9)
    v_mfma_f32_32x32x16_bf16 v[144:159], v[168:171], v[184:187], v[144:159]
    ds_read_b128 v[184:187], v225 offset:560
    v_mfma_f32_32x32x16_bf16 v[128:143], v[168:171], v[200:203], v[128:143]
    ds_read_b64_tr_b16 v[168:169], v224 offset:1312
    ds_read_b64_tr_b16 v[170:171], v224 offset:1280
    s_waitcnt lgkmcnt(9)
    v_mfma_f32_32x32x16_bf16 v[144:159], v[172:175], v[188:191], v[144:159]
    ds_read_b128 v[188:191], v225 offset:528
    v_mfma_f32_32x32x16_bf16 v[128:143], v[172:175], v[204:207], v[128:143]
    ds_read_b64_tr_b16 v[172:173], v224 offset:1440
    ds_read_b64_tr_b16 v[174:175], v224 offset:1408
    s_barrier
    s_waitcnt lgkmcnt(9)
    v_mfma_f32_32x32x16_bf16 v[144:159], v[160:163], v[192:195], v[144:159]
    ds_read_b128 v[192:195], v225 offset:496
    v_mfma_f32_32x32x16_bf16 v[128:143], v[160:163], v[176:179], v[128:143]
    ds_read_b64_tr_b16 v[160:161], v224 offset:1568
    ds_read_b64_tr_b16 v[162:163], v224 offset:1536
    s_waitcnt lgkmcnt(9)
    v_mfma_f32_32x32x16_bf16 v[144:159], v[164:167], v[196:199], v[144:159]
    ds_read_b128 v[196:199], v225 offset:464
    v_mfma_f32_32x32x16_bf16 v[128:143], v[164:167], v[180:183], v[128:143]
    ds_read_b64_tr_b16 v[164:165], v224 offset:1696
    ds_read_b64_tr_b16 v[166:167], v224 offset:1664
    s_waitcnt lgkmcnt(9)
    v_mfma_f32_32x32x16_bf16 v[144:159], v[168:171], v[200:203], v[144:159]
    ds_read_b128 v[200:203], v225 offset:432
    v_mfma_f32_32x32x16_bf16 v[128:143], v[168:171], v[184:187], v[128:143]
    ds_read_b64_tr_b16 v[168:169], v224 offset:1824
    ds_read_b64_tr_b16 v[170:171], v224 offset:1792
    s_waitcnt lgkmcnt(9)
    v_mfma_f32_32x32x16_bf16 v[144:159], v[172:175], v[204:207], v[144:159]
    ds_read_b128 v[204:207], v225 offset:400
    v_mfma_f32_32x32x16_bf16 v[128:143], v[172:175], v[188:191], v[128:143]
    ds_read_b64_tr_b16 v[172:173], v224 offset:1952
    ds_read_b64_tr_b16 v[174:175], v224 offset:1920
    s_waitcnt lgkmcnt(9)
    v_mfma_f32_32x32x16_bf16 v[144:159], v[160:163], v[176:179], v[144:159]
    v_mfma_f32_32x32x16_bf16 v[128:143], v[160:163], v[192:195], v[128:143]
    s_waitcnt lgkmcnt(6)
    v_mfma_f32_32x32x16_bf16 v[144:159], v[164:167], v[180:183], v[144:159]
    v_mfma_f32_32x32x16_bf16 v[128:143], v[164:167], v[196:199], v[128:143]
    s_waitcnt lgkmcnt(3)
    v_mfma_f32_32x32x16_bf16 v[144:159], v[168:171], v[184:187], v[144:159]
    v_mfma_f32_32x32x16_bf16 v[128:143], v[168:171], v[200:203], v[128:143]
    s_waitcnt lgkmcnt(0)
    v_mfma_f32_32x32x16_bf16 v[144:159], v[172:175], v[188:191], v[144:159]
    v_mfma_f32_32x32x16_bf16 v[128:143], v[172:175], v[204:207], v[128:143]
    s_nop 11
    s_branch L_ct_done
L_ct_b:
    ds_read_b64_tr_b16 v[160:161], v224 offset:2080
    ds_read_b64_tr_b16 v[162:163], v224 offset:2048
    ds_read_b128 v[192:195], v225 offset:496
    ds_read_b128 v[176:179], v225 offset:368
    ds_read_b64_tr_b16 v[164:165], v224 offset:2208
    ds_read_b64_tr_b16 v[166:167], v224 offset:2176
    ds_read_b128 v[196:199], v225 offset:464
    ds_read_b128 v[180:183], v225 offset:336
    ds_read_b64_tr_b16 v[168:169], v224 offset:2336
    ds_read_b64_tr_b16 v[170:171], v224 offset:2304
    ds_read_b128 v[200:203], v225 offset:432
    ds_read_b128 v[184:187], v225 offset:304
    ds_read_b64_tr_b16 v[172:173], v224 offset:2464
    ds_read_b64_tr_b16 v[174:175], v224 offset:2432
    ds_read_b128 v[204:207], v225 offset:400
    ds_read_b128 v[188:191], v225 offset:272
    s_waitcnt lgkmcnt(12)
    v_mfma_f32_32x32x16_bf16 v[144:159], v[160:163], v[192:195], 0
    ds_read_b128 v[192:195], v225 offset:240
    v_mfma_f32_32x32x16_bf16 v[128:143], v[160:163], v[176:179], 0
    ds_read_b64_tr_b16 v[160:161], v224 offset:2592
    ds_read_b64_tr_b16 v[162:163], v224 offset:2560
    s_waitcnt lgkmcnt(11)
    v_mfma_f32_32x32x16_bf16 v[144:159], v[164:167], v[196:199], v[144:159]
    ds_read_b128 v[196:199], v225 offset:208
    v_mfma_f32_32x32x16_bf16 v[128:143], v[164:167], v[180:183], v[128:143]
    ds_read_b64_tr_b16 v[164:165], v224 offset:2720
    ds_read_b64_tr_b16 v[166:167], v224 offset:2688
    s_waitcnt lgkmcnt(10)
    v_mfma_f32_32x32x16_bf16 v[144:159], v[168:171], v[200:203], v[144:159]
    ds_read_b128 v[200:203], v225 offset:176
    v_mfma_f32_32x32x16_bf16 v[128:143], v[168:171], v[184:187], v[128:143]
    ds_read_b64_tr_b16 v[168:169], v224 offset:2848
    ds_read_b64_tr_b16 v[170:171], v224 offset:2816
    s_waitcnt lgkmcnt(9)
    v_mfma_f32_32x32x16_bf16 v[144:159], v[172:175], v[204:207], v[144:159]
    ds_read_b128 v[204:207], v225 offset:144
    v_mfma_f32_32x32x16_bf16 v[128:143], v[172:175], v[188:191], v[128:143]
    ds_read_b64_tr_b16 v[172:173], v224 offset:2976
    ds_read_b64_tr_b16 v[174:175], v224 offset:2944
    s_waitcnt lgkmcnt(9)
    v_mfma_f32_32x32x16_bf16 v[144:159], v[160:163], v[176:179], v[144:159]
    ds_read_b128 v[176:179], v225 offset:112
    v_mfma_f32_32x32x16_bf16 v[128:143], v[160:163], v[192:195], v[128:143]
    ds_read_b64_tr_b16 v[160:161], v224 offset:3104
    ds_read_b64_tr_b16 v[162:163], v224 offset:3072
    s_waitcnt lgkmcnt(9)
    v_mfma_f32_32x32x16_bf16 v[144:159], v[164:167], v[180:183], v[144:159]
    ds_read_b128 v[180:183], v225 offset:80
    v_mfma_f32_32x32x16_bf16 v[128:143], v[164:167], v[196:199], v[128:143]
    ds_read_b64_tr_b16 v[164:165], v224 offset:3232
    ds_read_b64_tr_b16 v[166:167], v224 offset:3200
    s_waitcnt lgkmcnt(9)
    v_mfma_f32_32x32x16_bf16 v[144:159], v[168:171], v[184:187], v[144:159]
    ds_read_b128 v[184:187], v225 offset:48
    v_mfma_f32_32x32x16_bf16 v[128:143], v[168:171], v[200:203], v[128:143]
    ds_read_b64_tr_b16 v[168:169], v224 offset:3360
    ds_read_b64_tr_b16 v[170:171], v224 offset:3328
    s_waitcnt lgkmcnt(9)
    v_mfma_f32_32x32x16_bf16 v[144:159], v[172:175], v[188:191], v[144:159]
    ds_read_b128 v[188:191], v225 offset:16
    v_mfma_f32_32x32x16_bf16 v[128:143], v[172:175], v[204:207], v[128:143]
    ds_read_b64_tr_b16 v[172:173], v224 offset:3488
    ds_read_b64_tr_b16 v[174:175], v224 offset:3456
    s_barrier
    s_waitcnt lgkmcnt(9)
    v_mfma_f32_32x32x16_bf16 v[144:159], v[160:163], v[192:195], v[144:159]
    v_mfma_f32_32x32x16_bf16 v[128:143], v[160:163], v[176:179], v[128:143]
    ds_read_b64_tr_b16 v[160:161], v224 offset:3616
    ds_read_b64_tr_b16 v[162:163], v224 offset:3584
    s_waitcnt lgkmcnt(8)
    v_mfma_f32_32x32x16_bf16 v[144:159], v[164:167], v[196:199], v[144:159]
    v_mfma_f32_32x32x16_bf16 v[128:143], v[164:167], v[180:183], v[128:143]
    ds_read_b64_tr_b16 v[164:165], v224 offset:3744
    ds_read_b64_tr_b16 v[166:167], v224 offset:3712
    s_waitcnt lgkmcnt(7)
    v_mfma_f32_32x32x16_bf16 v[144:159], v[168:171], v[200:203], v[144:159]
    v_mfma_f32_32x32x16_bf16 v[128:143], v[168:171], v[184:187], v[128:143]
    ds_read_b64_tr_b16 v[168:169], v224 offset:3872
    ds_read_b64_tr_b16 v[170:171], v224 offset:3840
    s_waitcnt lgkmcnt(6)
    v_mfma_f32_32x32x16_bf16 v[144:159], v[172:175], v[204:207], v[144:159]
    v_mfma_f32_32x32x16_bf16 v[128:143], v[172:175], v[188:191], v[128:143]
    ds_read_b64_tr_b16 v[172:173], v224 offset:4000
    ds_read_b64_tr_b16 v[174:175], v224 offset:3968
    s_waitcnt lgkmcnt(6)
    v_mfma_f32_32x32x16_bf16 v[144:159], v[160:163], v[176:179], v[144:159]
    s_waitcnt lgkmcnt(4)
    v_mfma_f32_32x32x16_bf16 v[144:159], v[164:167], v[180:183], v[144:159]
    s_waitcnt lgkmcnt(2)
    v_mfma_f32_32x32x16_bf16 v[144:159], v[168:171], v[184:187], v[144:159]
    s_waitcnt lgkmcnt(0)
    v_mfma_f32_32x32x16_bf16 v[144:159], v[172:175], v[188:191], v[144:159]
    s_nop 1
L_ct_done:
    ds_write_b128 v233, v[128:131] offset:0
    ds_write_b128 v233, v[132:135] offset:32
    ds_write_b128 v233, v[136:139] offset:64
    ds_write_b128 v233, v[140:143] offset:96
    s_nop 7
    ds_write_b128 v233, v[144:147] offset:1152
    ds_write_b128 v233, v[148:151] offset:1184
    ds_write_b128 v233, v[152:155] offset:1216
    ds_write_b128 v233, v[156:159] offset:1248
    s_cmp_eq_u32 s66, 6
    s_cbranch_scc0 L_nocarry2
    v_bfe_u32 v16, v1, 2, 1
    v_mul_u32_u24 v16, 0x4c80, v16
    v_bfe_u32 v15, v1, 3, 1
    v_lshlrev_b32 v15, 2, v15
    v_and_b32 v17, 3, v1
    v_add_u32 v15, v15, v17
    v_mul_u32_u24 v15, 0x990, v15
    v_add_u32 v16, v16, v15
    v_add_u32 v16, 0x70, v16
    s_mov_b64 exec, 0xffff
    ds_write_b128 v16, v[250:253]
    s_mov_b64 exec, -1
L_nocarry2:
    s_waitcnt lgkmcnt(0)
    s_barrier
    ds_read_b32 v32, v227 offset:0
    ds_read_b32 v33, v228 offset:0
    ds_read_b32 v34, v229 offset:0
    ds_read_b32 v35, v230 offset:0
    ds_read_b32 v36, v227 offset:9792
    ds_read_b32 v37, v228 offset:9792
    ds_read_b32 v38, v229 offset:9792
    ds_read_b32 v39, v230 offset:9792
    ds_read_b32 v40, v227 offset:19584
    ds_read_b32 v41, v228 offset:19584
    ds_read_b32 v42, v229 offset:19584
    ds_read_b32 v43, v230 offset:19584
    s_waitcnt lgkmcnt(8)
    ds_read_b32 v44, v227 offset:29376
    ds_read_b32 v45, v228 offset:29376
    ds_read_b32 v46, v229 offset:29376
    ds_read_b32 v47, v230 offset:29376
    v_add_f32 v32, v32, v33
    v_add_f32 v34, v34, v35
    v_add_f32 v32, v32, v34
    s_waitcnt lgkmcnt(8)
    ds_read_b32 v48, v227 offset:1152
    ds_read_b32 v49, v228 offset:1152
    ds_read_b32 v50, v229 offset:1152
    ds_read_b32 v51, v230 offset:1152
    v_add_f32 v36, v36, v37
    v_add_f32 v38, v38, v39
    v_add_f32 v36, v36, v38
    v_add_f32 v36, v36, v32
    s_waitcnt lgkmcnt(8)
    ds_read_b32 v52, v227 offset:10944
    ds_read_b32 v53, v228 offset:10944
    ds_read_b32 v54, v229 offset:10944
    ds_read_b32 v55, v230 offset:10944
    v_add_f32 v40, v40, v41
    v_add_f32 v42, v42, v43
    v_add_f32 v40, v40, v42
    s_waitcnt lgkmcnt(8)
    ds_read_b32 v56, v227 offset:20736
    ds_read_b32 v57, v228 offset:20736
    ds_read_b32 v58, v229 offset:20736
    ds_read_b32 v59, v230 offset:20736
    v_add_f32 v44, v44, v45
    v_add_f32 v46, v46, v47
    v_add_f32 v44, v44, v46
    v_add_f32 v44, v44, v40
    v_cvt_pk_bf16_f32 v10, v36, v44
    s_waitcnt lgkmcnt(8)
    ds_read_b32 v60, v227 offset:30528
    ds_read_b32 v61, v228 offset:30528
    ds_read_b32 v62, v229 offset:30528
    ds_read_b32 v63, v230 offset:30528
    v_add_f32 v48, v48, v49
    v_add_f32 v50, v50, v51
    v_add_f32 v48, v48, v50
    s_waitcnt lgkmcnt(8)
    v_add_f32 v52, v52, v53
    v_add_f32 v54, v54, v55
    v_add_f32 v52, v52, v54
    v_add_f32 v52, v52, v48
    s_waitcnt lgkmcnt(4)
    v_add_f32 v56, v56, v57
    v_add_f32 v58, v58, v59
    v_add_f32 v56, v56, v58
    s_waitcnt lgkmcnt(0)
    v_add_f32 v60, v60, v61
    v_add_f32 v62, v62, v63
    v_add_f32 v60, v60, v62
    v_add_f32 v60, v60, v56
    v_cvt_pk_bf16_f32 v11, v52, v60
    s_sub_u32 s11, s38, 0x80000
    buffer_store_dword v10, v234, s[56:59], s11 offen
    buffer_store_dword v11, v234, s[56:59], s38 offen
    s_barrier
    s_barrier
    s_barrier
    s_barrier
L_fin:
    s_waitcnt lgkmcnt(0)
    s_barrier
    ds_read_b128 v[32:35], v241
    s_waitcnt lgkmcnt(0)
    buffer_store_dwordx4 v[32:35], v242, s[56:59], s15 offen
    s_endpgm
L_slow:
    s_cmp_eq_u32 s77, 0
    s_cbranch_scc1 L_slow_next
L_slow_go:
    s_add_u32 s73, s18, 0x300000
    v_mov_b32 v14, 0xff800000
    s_mov_b32 s79, 0
L_slow1:
    buffer_load_dwordx4 v[136:139], v2, s[48:51], s73 offen sc1
    s_add_u32 s73, s73, 0x400
    s_waitcnt vmcnt(0)
    v_mfma_f32_32x32x16_bf16 v[104:119], v[136:139], v[64:67], 0
    s_nop 11
    v_max3_f32 v14, v14, v104, v105
    v_max3_f32 v14, v14, v106, v107
    v_max3_f32 v14, v14, v108, v109
    v_max3_f32 v14, v14, v110, v111
    v_max3_f32 v14, v14, v112, v113
    v_max3_f32 v14, v14, v114, v115
    v_max3_f32 v14, v14, v116, v117
    v_max3_f32 v14, v14, v118, v119
    s_add_u32 s79, s79, 1
    s_cmp_lt_u32 s79, 64
    s_cbranch_scc1 L_slow1
    v_mov_b32 v15, v14
    s_nop 1
    v_permlane32_swap_b32 v14, v15
    s_nop 1
    v_max_f32 v14, v14, v15
    v_mul_f32 v120, -1.0, v14
    v_mul_f32 v121, -1.0, v14
    v_mul_f32 v122, -1.0, v14
    v_mul_f32 v123, -1.0, v14
    v_mul_f32 v124, -1.0, v14
    v_mul_f32 v125, -1.0, v14
    v_mul_f32 v126, -1.0, v14
    v_mul_f32 v127, -1.0, v14
    v_mul_f32 v128, -1.0, v14
    v_mul_f32 v129, -1.0, v14
    v_mul_f32 v130, -1.0, v14
    v_mul_f32 v131, -1.0, v14
    v_mul_f32 v132, -1.0, v14
    v_mul_f32 v133, -1.0, v14
    v_mul_f32 v134, -1.0, v14
    v_mul_f32 v135, -1.0, v14
    v_mov_b32 v164, 0
    v_mov_b32 v165, 0
    v_mov_b32 v166, 0
    v_mov_b32 v167, 0
    v_mov_b32 v168, 0
    v_mov_b32 v169, 0
    v_mov_b32 v170, 0
    v_mov_b32 v171, 0
    v_mov_b32 v172, 0
    v_mov_b32 v173, 0
    v_mov_b32 v174, 0
    v_mov_b32 v175, 0
    v_mov_b32 v176, 0
    v_mov_b32 v177, 0
    v_mov_b32 v178, 0
    v_mov_b32 v179, 0
    v_mov_b32 v208, 0x3f803f80
    v_mov_b32 v216, 0x3f803f80
    v_mov_b32 v209, 0x3f803f80
    v_mov_b32 v217, 0x3f803f80
    v_mov_b32 v210, 0x3f803f80
    v_mov_b32 v218, 0x3f803f80
    v_mov_b32 v211, 0x3f803f80
    v_mov_b32 v219, 0x3f803f80
    v_and_b32 v14, 15, v1
    v_lshrrev_b32 v15, 5, v1
    v_lshlrev_b32 v14, 4, v14
    v_lshl_add_u32 v14, v15, 8, v14
    s_add_u32 s73, s18, 0x300000
    s_add_u32 s74, s18, 0x500000
    s_mov_b32 s79, 0
L_slow2:
    buffer_load_dwordx4 v[136:139], v2, s[48:51], s73 offen sc1
    s_mov_b32 exec_lo, 0xffff
    s_mov_b32 exec_hi, 0xffff
    buffer_load_dwordx4 v[208:211], v14, s[48:51], s74 offen sc1
    buffer_load_dwordx4 v[216:219], v14, s[48:51], s74 offen offset:512 sc1
    s_mov_b64 exec, -1
    s_add_u32 s73, s73, 0x400
    s_add_u32 s74, s74, 0x400
    s_waitcnt vmcnt(0)
    v_mfma_f32_32x32x16_bf16 v[104:119], v[136:139], v[64:67], v[120:135]
    s_nop 11
    v_exp_f32 v104, v104
    v_exp_f32 v105, v105
    v_exp_f32 v106, v106
    v_exp_f32 v107, v107
    v_exp_f32 v108, v108
    v_exp_f32 v109, v109
    v_exp_f32 v110, v110
    v_exp_f32 v111, v111
    v_exp_f32 v112, v112
    v_exp_f32 v113, v113
    v_exp_f32 v114, v114
    v_exp_f32 v115, v115
    v_exp_f32 v116, v116
    v_exp_f32 v117, v117
    v_exp_f32 v118, v118
    v_exp_f32 v119, v119
    s_nop 1
    v_smfmac_f32_32x32x32_bf16 v[164:179], v[208:211], v[104:111], v255
    v_smfmac_f32_32x32x32_bf16 v[164:179], v[216:219], v[112:119], v255
    s_add_u32 s79, s79, 1
    s_cmp_lt_u32 s79, 64
    s_nop 3
    s_cbranch_scc1 L_slow2
    s_nop 11
    v_rcp_f32 v14, v172
    s_nop 0
    v_mul_f32 v164, v164, v14
    v_mul_f32 v165, v165, v14
    v_mul_f32 v166, v166, v14
    v_mul_f32 v167, v167, v14
    v_mul_f32 v168, v168, v14
    v_mul_f32 v169, v169, v14
    v_mul_f32 v170, v170, v14
    v_mul_f32 v171, v171, v14
    v_cvt_pk_bf16_f32 v32, v164, v165
    v_cvt_pk_bf16_f32 v33, v166, v167
    v_cvt_pk_bf16_f32 v34, v168, v169
    v_cvt_pk_bf16_f32 v35, v170, v171
    s_nop 1
    v_permlane32_swap_b32 v32, v34
    v_permlane32_swap_b32 v33, v35
    buffer_store_dwordx4 v[32:35], v2, s[48:51], s13 offen offset:0 sc1
L_slow_next:
    s_cmp_eq_u32 s78, 0
    s_cbranch_scc1 L_attn_ok
    s_mov_b32 s78, 0
    v_mov_b32 v64, v68
    v_mov_b32 v65, v69
    v_mov_b32 v66, v70
    v_mov_b32 v67, v71
    s_add_u32 s13, s13, 0x400
    s_branch L_slow_go
L_end:
    s_endpgm
.section .rodata,"a"
.p2align 6
.amdhsa_kernel concat_heads__ssm_conv_s4__softmax_full_mha__prompt_kernel
  .amdhsa_next_free_vgpr 256
  .amdhsa_next_free_sgpr 102
  .amdhsa_accum_offset 256
  .amdhsa_group_segment_fixed_size 0
  .amdhsa_kernarg_size 120
  .amdhsa_user_sgpr_count 2
  .amdhsa_user_sgpr_kernarg_segment_ptr 1
  .amdhsa_system_sgpr_workgroup_id_x 1
.end_amdhsa_kernel
```
